```python
import torch

def _softmax(x, axis=-1):
    return torch.softmax(x, dim=axis)
def _gelu(x):
    return torch.nn.functional.gelu(x, approximate="tanh")
def _silu(x):
    return torch.nn.functional.silu(x)
def _sigmoid(x):
    return torch.sigmoid(x)
def _layernorm(x, axis=-1, eps=1e-5):
    m = x.mean(dim=axis, keepdim=True)
    v = x.var(dim=axis, keepdim=True, unbiased=False)
    return (x - m) / torch.sqrt(v + eps)
def _scatter_add(tgt, idx, src, axis=0):
    return tgt.clone().index_add_(axis, idx, src)
def _segment_sum(src, seg, n):
    out = torch.zeros((n,) + src.shape[1:], dtype=src.dtype)
    return out.index_add_(0, seg, src)
def _pad(x, pw):
    flat = tuple(v for pair in reversed(pw) for v in pair)
    return torch.nn.functional.pad(x, flat)

kernel_name = 'parallel_sum__softmax_full_mha__dense_activation_squared_relu__prompt'

def setup_inputs():

    _w = (lambda a: (lambda t: t.to(torch.bfloat16) if t.is_floating_point() else t)(torch.as_tensor(a)))
    def _A_setup():
        B, S, D = 1, 2048, 640
        return {
            "x": _w((lambda *s: torch.randn(*s, dtype=torch.bfloat16) * 0.05)(B, S, D)),
            "wqkv": _w((lambda *s: torch.randn(*s, dtype=torch.bfloat16) * 0.2)(D, 3 * D)),
            "wo": _w((lambda *s: torch.randn(*s, dtype=torch.bfloat16) * 0.1)(D, D)),
        }
    _A_in = _A_setup()

    def _B_setup():
        B, S, D, F = 1, 2048, 640, 1728
        return {
            "x": _w((lambda *s: torch.randn(*s, dtype=torch.bfloat16) * 0.05)(B, S, D)),
            "w1": _w((lambda *s: torch.randn(*s, dtype=torch.bfloat16) * 0.1)(D, F)),
            "b1": _w((lambda *s: torch.randn(*s, dtype=torch.bfloat16) * 0.1)(F)),
            "w2": _w((lambda *s: torch.randn(*s, dtype=torch.bfloat16) * 0.1)(F, D)),
            "b2": _w((lambda *s: torch.randn(*s, dtype=torch.bfloat16) * 0.1)(D)),
        }
    _B_in = _B_setup()

    return {
        "A_x": _A_in["x"],
        "A_wqkv": _A_in["wqkv"],
        "A_wo": _A_in["wo"],
        "B_x": _B_in["x"],
        "B_w1": _B_in["w1"],
        "B_b1": _B_in["b1"],
        "B_w2": _B_in["w2"],
        "B_b2": _B_in["b2"],
    }

def reference(A_x, A_wqkv, A_wo, B_x, B_w1, B_b1, B_w2, B_b2):
    def _A_ref(x, wqkv, wo):
        B, S, D = x.shape
        H = 32; Dh = D // H
        qkv = (lambda x, *d: x.permute(*d))((x @ wqkv).reshape(B, S, 3, H, Dh), 2, 0, 3, 1, 4)
        q, k, v = qkv[0], qkv[1], qkv[2]
        scale = Dh ** -0.5
        scores = torch.einsum("bhqd,bhkd->bhqk", q, k) * scale
        p = _softmax(scores, axis=-1)
        o = torch.einsum("bhqk,bhkd->bhqd", p, v)
        return (lambda x, *d: x.permute(*d))(o, 0, 2, 1, 3).reshape(B, S, D) @ wo

    def _B_ref(x, w1, b1, w2, b2):
        h = torch.einsum("bsd,df->bsf", x, w1) + b1
        zero = torch.zeros_like(h)
        r = torch.where(h > zero, h, zero)
        h = r * r
        out = torch.einsum("bsf,fd->bsd", h, w2) + b2
        return out

    x = A_x
    xn = _layernorm(x, axis=-1)
    return x + _A_ref(xn, A_wqkv, A_wo) + _B_ref(xn, B_w1, B_b1, B_w2, B_b2)
```

```asm
; @launch grid=(256,1,1) block=(512,1,1) lds=163840
.amdgcn_target "amdgcn-amd-amdhsa--gfx950"
.text
.globl parallel_sum__softmax_full_mha__dense_activation_squared_relu__prompt_kernel
.p2align 8
.type parallel_sum__softmax_full_mha__dense_activation_squared_relu__prompt_kernel,@function
parallel_sum__softmax_full_mha__dense_activation_squared_relu__prompt_kernel:
    s_cmp_ge_u32 s2, 256
    s_cbranch_scc1 L_end
    s_load_dwordx16 s[4:19], s[0:1], 0
    s_load_dwordx2 s[22:23], s[0:1], 80
    s_load_dwordx2 s[20:21], s[0:1], 64
    v_lshrrev_b32 v2, 6, v0
    v_and_b32 v1, 63, v0
    s_and_b32 s61, s2, 1
    v_readfirstlane_b32 s44, v2
    s_bfe_u32 s46, s2, 0x30003
    s_bfe_u32 s58, s2, 0x20001
    s_lshr_b32 s59, s2, 6
    s_lshl2_add_u32 s51, s58, s59
    s_and_b32 s60, s46, 3
    s_lshl2_add_u32 s60, s60, 3
    s_lshl3_add_u32 s46, s61, s46
    s_cmp_gt_u32 s51, s60
    s_subb_u32 s47, s51, 0
    s_cmp_eq_u32 s51, s60
    s_cselect_b32 s47, 15, s47
    s_mov_b32 s39, 0x00020000
    s_and_b32 s45, s44, 3
    s_cmp_ge_u32 s44, 4
    s_cbranch_scc1 L_p_col
    s_mov_b32 s3, 0
    s_lshl4_add_u32 s58, s46, s47
    s_lshl1_add_u32 s58, s58, s45
    s_mul_i32 s59, s58, 5120
    s_cmp_eq_u32 s47, 15
    s_cselect_b32 s75, 0, 2
    s_cmp_eq_u32 s47, 14
    s_cselect_b32 s75, 4, s75
    v_lshrrev_b32 v2, 4, v1
    v_and_b32 v3, 7, v1
    v_lshrrev_b32 v4, 3, v1
    v_mul_u32_u24 v4, 640, v4
    s_movk_i32 s60, 128
    s_mov_b32 s38, 2621440
    s_cmp_lt_u32 s45, s75
    s_waitcnt lgkmcnt(0)
    s_mov_b64 s[36:37], s[4:5]
    s_branch L_p_ld
L_p_col:
    s_setprio 2
    s_mov_b32 s3, 1
    s_bfe_u32 s59, s2, 0x10005
    s_lshl1_add_u32 s59, s47, s59
    s_bfe_u32 s58, s2, 0x10003
    s_lshl1_add_u32 s58, s61, s58
    s_mul_i32 s71, s58, 29184
    s_lshl2_add_u32 s58, s58, s45
    s_lshl_b32 s58, s58, 3
    s_lshl_b32 s60, s61, 8
    s_add_u32 s58, s58, s60
    v_lshrrev_b32 v2, 3, v1
    v_and_b32 v3, 7, v1
    s_bitcmp0_b32 s2, 4
    s_cselect_b32 s75, 30, 57
    s_movk_i32 s60, 3840
    s_cselect_b32 s60, s60, 3456
    s_cselect_b32 s72, 0, 30
    s_mul_i32 s38, s60, 640
    s_mul_i32 s58, s58, s60
    v_mul_u32_u24 v4, s60, v2
    s_waitcnt lgkmcnt(0)
    s_cselect_b64 s[36:37], s[6:7], s[12:13]
    s_add_u32 s72, s72, s59
    s_lshl_b32 s59, s59, 7
    s_add_u32 s59, s59, s58
    s_lshl_b32 s60, s60, 6
    s_cmp_lt_u32 s72, s75
    s_cselect_b32 s75, 3, 7
L_p_ld:
    v_lshl_add_u32 v4, v3, 4, v4
    s_cbranch_scc0 L_p_id
    buffer_load_dwordx4 v[32:35], v4, s[36:39], s59 offen
    s_add_u32 s59, s59, s60
    buffer_load_dwordx4 v[36:39], v4, s[36:39], s59 offen
    s_add_u32 s59, s59, s60
    buffer_load_dwordx4 v[40:43], v4, s[36:39], s59 offen
    s_add_u32 s59, s59, s60
    buffer_load_dwordx4 v[44:47], v4, s[36:39], s59 offen
    s_add_u32 s59, s59, s60
    buffer_load_dwordx4 v[48:51], v4, s[36:39], s59 offen
    s_add_u32 s59, s59, s60
L_p_id:
    s_xor_b32 s60, s46, 2
    s_and_b32 s60, s60, 3
    s_lshl2_add_u32 s60, s60, 3
    s_cmp_eq_u32 s51, s60
    s_cselect_b32 s58, 15, s47
    s_cmp_gt_u32 s51, s60
    s_subb_u32 s51, s58, 0
    s_cmp_eq_u32 s47, 15
    s_cbranch_scc1 L_near
L_p_go:
    s_cmp_eq_u32 s3, 0
    s_cbranch_scc1 L_g0
    s_lshl_b32 s64, s45, 12
    s_mul_i32 s61, s61, 5
    s_mul_i32 s62, s61, 128
    s_mul_i32 s65, s61, 245760
    s_mul_i32 s68, s61, 221184
    v_lshrrev_b32 v4, 4, v1
    v_xor_b32 v4, v4, v3
    s_lshl_b32 s59, s46, 2
    s_add_u32 s59, s59, s45
    s_mul_i32 s59, s59, 40960
    v_mul_u32_u24 v5, 1280, v2
    v_add_u32 v5, s59, v5
    v_lshl_add_u32 v11, v4, 4, v5
    v_xor_b32 v4, 4, v4
    v_lshl_add_u32 v12, v4, 4, v5
    v_add_u32 v13, 18432, v11
    v_add_u32 v14, 27648, v12
    v_add_u32 v12, 9216, v12
    v_and_b32 v80, 48, v1
    v_lshl_add_u32 v80, v3, 6, v80
    s_mov_b32 s28, s4
    s_mov_b32 s29, s5
    s_mov_b32 s30, 2621440
    s_mov_b32 s31, 0x00020000
    s_cmp_eq_u32 s45, 0
    s_cbranch_scc0 L_tc
    s_getpc_b64 s[36:37]
L_pc:
    s_sub_u32 s36, s36, L_pc-parallel_sum__softmax_full_mha__dense_activation_squared_relu__prompt_kernel
    s_subb_u32 s37, s37, 0
    s_mov_b32 s38, L_end-parallel_sum__softmax_full_mha__dense_activation_squared_relu__prompt_kernel
    s_lshr_b32 s58, s2, 3
    s_mul_i32 s58, s58, 1152
    v_lshlrev_b32 v4, 7, v1
    s_mov_b64 exec, 0x1ff
    buffer_load_dword v226, v4, s[36:39], s58 offen
    s_mov_b64 exec, -1
L_tc:
    s_mov_b32 s36, s14
    s_mov_b32 s37, s15
    s_mov_b32 s38, 3456
    s_mov_b32 s39, 0x00020000
    s_lshl_b32 s60, s51, 8
    v_lshlrev_b32 v4, 2, v1
    buffer_load_dword v28, v4, s[36:39], s60 offen
    s_mov_b32 s24, s22
    s_mov_b32 s25, s23
    s_mov_b32 s26, 21170304
    s_mov_b32 s27, 0x00020000
    s_mov_b32 s58, 21170176
    s_load_dword s55, s[22:23], s58
    v_lshrrev_b32 v2, 4, v1
    v_lshlrev_b32 v3, 1, v2
    v_xor_b32 v3, v3, v1
    v_and_b32 v3, 15, v3
    s_lshl_b32 s59, s47, 8
    s_mul_i32 s58, s45, 61440
    s_add_u32 s59, s59, s58
    v_mul_u32_u24 v2, 3840, v2
    v_add_u32 v2, s59, v2
    v_lshl_add_u32 v15, v3, 4, v2
    v_xor_b32 v3, 8, v3
    v_lshl_add_u32 v17, v3, 4, v2
    v_add_u32 v16, 14336, v15
    v_add_u32 v18, 43008, v17
    v_add_u32 v17, 28672, v17
    v_lshrrev_b32 v2, 4, v1
    v_lshlrev_b32 v3, 1, v2
    v_xor_b32 v3, v3, v1
    v_and_b32 v3, 15, v3
    s_lshl_b32 s59, s51, 8
    s_mul_i32 s58, s45, 55296
    s_add_u32 s59, s59, s58
    v_mul_u32_u24 v2, 3456, v2
    v_add_u32 v2, s59, v2
    v_lshl_add_u32 v19, v3, 4, v2
    v_xor_b32 v3, 8, v3
    v_lshl_add_u32 v21, v3, 4, v2
    v_add_u32 v20, 12800, v19
    v_add_u32 v22, 38400, v21
    v_add_u32 v21, 25600, v21
    s_mov_b32 s32, s6
    s_mov_b32 s33, s7
    s_mov_b32 s34, 2457600
    s_mov_b32 s35, 0x00020000
    s_mov_b32 s40, s12
    s_mov_b32 s41, s13
    s_mov_b32 s42, 2211840
    s_mov_b32 s43, 0x00020000
    s_cmp_lt_u32 s51, 14
    s_cselect_b32 s42, s42, 0
    s_lshl_b32 s72, s72, 9
    s_add_u32 s71, s71, s72
    s_add_u32 s71, s71, 20627456
    s_and_b32 s59, s45, 1
    v_lshl_add_u32 v25, s59, 6, v1
    s_lshl_b32 s61, s46, 11
    v_lshl_add_u32 v24, v25, 4, s61
    s_add_u32 s60, s51, 15
    s_cmp_eq_u32 s59, 0
    s_cselect_b32 s59, s47, s60
    s_lshl_b32 s59, s59, 6
    v_add_u32 v26, s59, v1
    v_min_u32 v26, 1823, v26
    v_lshlrev_b32 v26, 4, v26
    s_mov_b32 s69, 131072
    v_lshrrev_b32 v23, 1, v80
    v_add_u32 v23, 150016, v23
    s_cmp_lt_u32 s47, 15
    s_cbranch_scc1 L_g1_on
    s_and_b32 s58, s2, 7
    s_lshr_b32 s59, s2, 3
    s_and_b32 s60, s59, 3
    s_lshl_b32 s48, s58, 2
    s_add_u32 s48, s48, s60
    s_lshr_b32 s49, s59, 2
    s_and_b32 s54, s48, 1
    s_lshr_b32 s60, s48, 1
    s_mul_i32 s60, s60, 5
    s_add_u32 s53, s60, 2
    s_mul_i32 s61, s54, 3
    s_add_u32 s52, s60, s61
    s_lshl_b32 s52, s52, 15
    s_lshl_b32 s53, s53, 15
    v_and_b32 v2, 31, v1
    v_lshrrev_b32 v3, 5, v1
    v_bfe_u32 v5, v2, 2, 1
    v_bfe_u32 v6, v2, 3, 2
    v_lshl_add_u32 v5, v5, 2, v6
    v_and_b32 v6, 3, v2
    v_lshl_add_u32 v4, v5, 2, v6
    v_lshlrev_b32 v5, 4, v4
    v_lshl_add_u32 v8, v3, 15, v5
    v_add_u32 v8, s52, v8
    v_lshl_add_u32 v9, v3, 9, v5
    v_add_u32 v9, s53, v9
    v_cmp_le_u32 vcc, 20, v1
    s_lshl_b32 s58, s45, 10
    s_andn2_b32 s74, 1, s2
    s_mul_i32 s74, s74, 0
    v_cndmask_b32 v4, 0, 1, vcc
    v_mul_u32_u24 v5, 20, v4
    v_sub_u32 v5, v1, v5
    v_mul_u32_u24 v10, 10240, v4
    v_lshrrev_b32 v6, 1, v5
    v_xor_b32 v6, v6, v5
    v_and_b32 v6, 4, v6
    v_lshlrev_b32 v7, 1, v6
    v_or_b32 v6, v6, v7
    v_xor_b32 v4, v6, v5
    s_lshl_b32 s58, s54, 2
    s_mul_i32 s59, s54, -16
    v_cmp_gt_u32 vcc, 16, v5
    v_add_u32 v4, s58, v4
    v_add_u32 v6, s59, v5
    v_cndmask_b32 v4, v6, v4, vcc
    s_mul_i32 s58, s48, 320
    v_lshl_add_u32 v10, v4, 4, v10
    v_add_u32 v10, s58, v10
    v_min_u32 v253, 47, v1
    v_lshrrev_b32 v5, 4, v253
    v_and_b32 v253, 15, v253
    v_mul_u32_u24 v5, 22784, v5
    v_mul_u32_u24 v253, 656, v253
    v_add_u32 v253, v253, v5
    v_add_u32 v253, 108416, v253
    v_and_b32 v2, 1, v1
    s_mul_i32 s58, s48, 20
    v_mad_u32_u24 v3, v2, 19, s58
    v_lshrrev_b32 v3, 6, v3
    v_lshrrev_b32 v2, 1, v1
    v_min_u32 v2, 2, v2
    v_mad_u32_u24 v3, v2, 10, v3
    v_mov_b32 v4, s74
    s_mov_b64 exec, 3
    v_mov_b32 v4, s49
    s_mov_b64 exec, -1
    v_lshl_add_u32 v4, v4, 2, s45
    v_lshl_add_u32 v252, v3, 5, v4
    v_lshlrev_b32 v252, 7, v252
    v_and_b32 v2, 1, v1
    s_mul_i32 s58, s48, 20
    v_mad_u32_u24 v3, v2, 19, s58
    v_lshrrev_b32 v3, 6, v3
    v_bfe_u32 v2, v1, 1, 1
    v_mad_u32_u24 v3, v2, 10, v3
    v_add_u32 v3, 10, v3
    v_and_b32 v2, 28, v1
    v_add_u32 v2, s45, v2
    v_lshl_add_u32 v251, v3, 5, v2
    v_lshlrev_b32 v251, 7, v251
    v_and_b32 v2, 31, v1
    v_lshrrev_b32 v3, 5, v1
    s_lshl_b32 s58, s49, 2
    s_add_u32 s58, s58, s45
    s_lshl_b32 s58, s58, 10
    s_lshl_b32 s59, s54, 3
    s_add_u32 s60, s58, s59
    v_lshlrev_b32 v4, 4, v2
    v_lshl_add_u32 v247, v3, 15, v4
    v_add_u32 v247, s58, v247
    v_add_u32 v248, s60, v4
    v_lshl_add_u32 v249, v1, 4, s58
    s_lshl_b32 s58, s48, 2
    s_add_u32 s58, s58, s45
    v_and_b32 v4, 15, v1
    v_lshl_add_u32 v4, s58, 4, v4
    v_lshrrev_b32 v5, 4, v1
    v_lshlrev_b32 v254, 15, v5
    v_lshl_add_u32 v254, v4, 4, v254
    v_mul_u32_u24 v255, 1280, v4
    v_min_u32 v5, 26, v2
    v_lshl_add_u32 v246, v5, 5, s48
    v_lshl_add_u32 v5, v2, 2, s45
    v_min_u32 v5, 53, v5
    v_subrev_u32 v6, 16, v2
    v_min_u32 v6, 4, v6
    v_lshl_add_u32 v6, v6, 2, s45
    s_lshl_b32 s58, s49, 7
    s_add_u32 s58, s58, 1024
    s_add_u32 s70, s58, s50
    s_add_u32 s59, s58, 54
    s_mov_b32 exec_lo, 0
    v_add_u32 v246, s58, v5
    s_mov_b32 exec_hi, 0xffff0000
    v_add_u32 v246, s59, v6
    s_mov_b32 exec_hi, 0xffffffff
    v_and_b32 v246, 15, v2
    v_add_u32 v246, 1024, v246
    s_mov_b64 exec, -1
    v_lshlrev_b32 v246, 7, v246
    s_lshr_b32 s58, s48, 2
    v_lshl_add_u32 v250, s58, 5, v2
    s_andn2_b32 s58, s2, 8
    s_mov_b32 exec_lo, 0
    v_mov_b32 v250, s58
    s_cmp_eq_u32 s2, 0
    s_cselect_b64 exec, -1, 0
    v_lshl_add_u32 v250, s45, 6, v1
    s_mov_b64 exec, -1
    v_lshlrev_b32 v250, 7, v250
    s_waitcnt lgkmcnt(0)
    s_add_u32 s55, s55, 1
    s_branch L_tr
L_tr_f:
    s_add_u32 s70, s46, 1024
    s_cmp_eq_u32 s45, 0
    s_cbranch_scc0 L_trf
    s_lshl_b32 s58, s70, 7
    s_add_u32 s58, s58, 20875264
    v_lshlrev_b32 v6, 2, v1
    v_mov_b32 v5, s55
    s_mov_b32 exec_hi, 0
    buffer_store_dword v5, v6, s[24:27], s58 offen sc1
    s_mov_b64 exec, -1
L_trf:
    s_branch L_b_last
L_g1_on:
    s_add_u32 m0, s64, 0
    s_add_u32 s63, s62, 0
    buffer_load_dwordx4 v11, s[28:31], s63 offen offset:0 lds
    buffer_load_dwordx4 v12, s[28:31], s63 offen offset:1024 lds
    buffer_load_dwordx4 v13, s[28:31], s63 offen offset:2048 lds
    buffer_load_dwordx4 v14, s[28:31], s63 offen offset:3072 lds
    s_add_u32 m0, s64, 16384
    s_add_u32 s63, s65, 0
    buffer_load_dwordx4 v15, s[32:35], s63 offen offset:0 lds
    buffer_load_dwordx4 v16, s[32:35], s63 offen offset:1024 lds
    buffer_load_dwordx4 v17, s[32:35], s63 offen offset:2048 lds
    buffer_load_dwordx4 v18, s[32:35], s63 offen offset:3072 lds
    s_add_u32 m0, s64, 32768
    s_add_u32 s63, s68, 0
    buffer_load_dwordx4 v19, s[40:43], s63 offen offset:0 lds
    buffer_load_dwordx4 v20, s[40:43], s63 offen offset:1024 lds
    buffer_load_dwordx4 v21, s[40:43], s63 offen offset:2048 lds
    buffer_load_dwordx4 v22, s[40:43], s63 offen offset:3072 lds
    s_add_u32 m0, s64, 49152
    s_add_u32 s63, s62, 128
    buffer_load_dwordx4 v11, s[28:31], s63 offen offset:0 lds
    buffer_load_dwordx4 v12, s[28:31], s63 offen offset:1024 lds
    buffer_load_dwordx4 v13, s[28:31], s63 offen offset:2048 lds
    buffer_load_dwordx4 v14, s[28:31], s63 offen offset:3072 lds
    s_add_u32 m0, s64, 65536
    s_add_u32 s63, s65, 245760
    buffer_load_dwordx4 v15, s[32:35], s63 offen offset:0 lds
    buffer_load_dwordx4 v16, s[32:35], s63 offen offset:1024 lds
    buffer_load_dwordx4 v17, s[32:35], s63 offen offset:2048 lds
    buffer_load_dwordx4 v18, s[32:35], s63 offen offset:3072 lds
    s_add_u32 m0, s64, 81920
    s_add_u32 s63, s68, 221184
    buffer_load_dwordx4 v19, s[40:43], s63 offen offset:0 lds
    buffer_load_dwordx4 v20, s[40:43], s63 offen offset:1024 lds
    buffer_load_dwordx4 v21, s[40:43], s63 offen offset:2048 lds
    buffer_load_dwordx4 v22, s[40:43], s63 offen offset:3072 lds
    s_waitcnt lgkmcnt(0)
    s_add_u32 s55, s55, 1
    s_waitcnt vmcnt(12)
    s_barrier
    s_setprio 2
    s_add_u32 m0, s64, 98304
    s_add_u32 s63, s62, 256
    buffer_load_dwordx4 v11, s[28:31], s63 offen offset:0 lds
    v_lshlrev_b32 v72, 16, v32
    v_and_b32 v73, 0xffff0000, v32
    v_lshlrev_b32 v74, 16, v33
    v_and_b32 v75, 0xffff0000, v33
    v_lshlrev_b32 v76, 16, v34
    v_and_b32 v77, 0xffff0000, v34
    v_lshlrev_b32 v78, 16, v35
    v_and_b32 v79, 0xffff0000, v35
    buffer_load_dwordx4 v12, s[28:31], s63 offen offset:1024 lds
    v_lshlrev_b32 v4, 16, v36
    v_and_b32 v5, 0xffff0000, v36
    v_add_f32 v72, v72, v4
    v_add_f32 v73, v73, v5
    v_lshlrev_b32 v6, 16, v37
    v_and_b32 v7, 0xffff0000, v37
    v_add_f32 v74, v74, v6
    v_add_f32 v75, v75, v7
    buffer_load_dwordx4 v13, s[28:31], s63 offen offset:2048 lds
    v_lshlrev_b32 v4, 16, v38
    v_and_b32 v5, 0xffff0000, v38
    v_add_f32 v76, v76, v4
    v_add_f32 v77, v77, v5
    v_lshlrev_b32 v6, 16, v39
    v_and_b32 v7, 0xffff0000, v39
    v_add_f32 v78, v78, v6
    v_add_f32 v79, v79, v7
    buffer_load_dwordx4 v14, s[28:31], s63 offen offset:3072 lds
    v_lshlrev_b32 v4, 16, v40
    v_and_b32 v5, 0xffff0000, v40
    v_add_f32 v72, v72, v4
    v_add_f32 v73, v73, v5
    v_lshlrev_b32 v6, 16, v41
    v_and_b32 v7, 0xffff0000, v41
    v_add_f32 v74, v74, v6
    v_add_f32 v75, v75, v7
    s_add_u32 m0, s64, 114688
    s_add_u32 s63, s65, 491520
    buffer_load_dwordx4 v15, s[32:35], s63 offen offset:0 lds
    v_lshlrev_b32 v4, 16, v42
    v_and_b32 v5, 0xffff0000, v42
    v_add_f32 v76, v76, v4
    v_add_f32 v77, v77, v5
    v_lshlrev_b32 v6, 16, v43
    v_and_b32 v7, 0xffff0000, v43
    v_add_f32 v78, v78, v6
    v_add_f32 v79, v79, v7
    buffer_load_dwordx4 v16, s[32:35], s63 offen offset:1024 lds
    v_lshlrev_b32 v4, 16, v44
    v_and_b32 v5, 0xffff0000, v44
    v_add_f32 v72, v72, v4
    v_add_f32 v73, v73, v5
    v_lshlrev_b32 v6, 16, v45
    v_and_b32 v7, 0xffff0000, v45
    v_add_f32 v74, v74, v6
    v_add_f32 v75, v75, v7
    buffer_load_dwordx4 v17, s[32:35], s63 offen offset:2048 lds
    v_lshlrev_b32 v4, 16, v46
    v_and_b32 v5, 0xffff0000, v46
    v_add_f32 v76, v76, v4
    v_add_f32 v77, v77, v5
    v_lshlrev_b32 v6, 16, v47
    v_and_b32 v7, 0xffff0000, v47
    v_add_f32 v78, v78, v6
    v_add_f32 v79, v79, v7
    buffer_load_dwordx4 v18, s[32:35], s63 offen offset:3072 lds
    v_lshlrev_b32 v4, 16, v48
    v_and_b32 v5, 0xffff0000, v48
    v_add_f32 v72, v72, v4
    v_add_f32 v73, v73, v5
    v_lshlrev_b32 v6, 16, v49
    v_and_b32 v7, 0xffff0000, v49
    v_add_f32 v74, v74, v6
    v_add_f32 v75, v75, v7
    s_add_u32 m0, s64, 131072
    s_add_u32 s63, s68, 442368
    buffer_load_dwordx4 v19, s[40:43], s63 offen offset:0 lds
    v_lshlrev_b32 v4, 16, v50
    v_and_b32 v5, 0xffff0000, v50
    v_add_f32 v76, v76, v4
    v_add_f32 v77, v77, v5
    v_lshlrev_b32 v6, 16, v51
    v_and_b32 v7, 0xffff0000, v51
    v_add_f32 v78, v78, v6
    v_add_f32 v79, v79, v7
    buffer_load_dwordx4 v20, s[40:43], s63 offen offset:1024 lds
    s_lshl_b32 s58, s45, 8
    v_add_u32 v4, s58, v23
    v_permlane32_swap_b32 v72, v76
    v_permlane32_swap_b32 v73, v77
    v_permlane32_swap_b32 v74, v78
    v_permlane32_swap_b32 v75, v79
    v_add_f32 v72, v72, v76
    v_add_f32 v73, v73, v77
    buffer_load_dwordx4 v21, s[40:43], s63 offen offset:2048 lds
    v_add_f32 v74, v74, v78
    v_add_f32 v75, v75, v79
    s_nop 1
    v_permlane16_swap_b32 v72, v74
    v_permlane16_swap_b32 v73, v75
    v_add_f32 v72, v72, v74
    v_add_f32 v73, v73, v75
    s_nop 1
    buffer_load_dwordx4 v22, s[40:43], s63 offen offset:3072 lds
    v_add_f32_dpp v72, v72, v72 row_ror:8 row_mask:0xf bank_mask:0xf
    v_add_f32_dpp v73, v73, v73 row_ror:8 row_mask:0xf bank_mask:0xf
    ds_write_b64 v4, v[72:73]
    s_cmp_eq_u32 s45, 2
    s_cbranch_scc0 L_pr
    s_lshl4_add_u32 s58, s46, s47
    s_lshl_b32 s58, s58, 7
    s_add_u32 s58, s58, 20594688
    v_lshlrev_b32 v4, 4, v1
    v_add_u32 v5, 151040, v4
    s_cmp_eq_u32 s47, 14
    s_movk_i32 s59, 0xff
    s_cselect_b32 exec_lo, 0xffff, s59
    s_mov_b32 exec_hi, 0
    ds_read_b128 v[72:75], v5
    s_waitcnt lgkmcnt(0)
    buffer_store_dwordx4 v[72:75], v4, s[24:27], s58 offen sc1
    s_mov_b64 exec, -1
L_pr:
    s_waitcnt lgkmcnt(0)
    s_waitcnt vmcnt(12)
    s_barrier
    s_add_u32 m0, s64, 0
    s_add_u32 s63, s62, 384
    buffer_load_dwordx4 v11, s[28:31], s63 offen offset:0 lds
    buffer_load_dwordx4 v12, s[28:31], s63 offen offset:1024 lds
    buffer_load_dwordx4 v13, s[28:31], s63 offen offset:2048 lds
    buffer_load_dwordx4 v14, s[28:31], s63 offen offset:3072 lds
    s_add_u32 m0, s64, 16384
    s_add_u32 s63, s65, 737280
    buffer_load_dwordx4 v15, s[32:35], s63 offen offset:0 lds
    buffer_load_dwordx4 v16, s[32:35], s63 offen offset:1024 lds
    buffer_load_dwordx4 v17, s[32:35], s63 offen offset:2048 lds
    buffer_load_dwordx4 v18, s[32:35], s63 offen offset:3072 lds
    s_add_u32 m0, s64, 32768
    s_add_u32 s63, s68, 663552
    buffer_load_dwordx4 v19, s[40:43], s63 offen offset:0 lds
    buffer_load_dwordx4 v20, s[40:43], s63 offen offset:1024 lds
    buffer_load_dwordx4 v21, s[40:43], s63 offen offset:2048 lds
    buffer_load_dwordx4 v22, s[40:43], s63 offen offset:3072 lds
    s_cmp_eq_u32 s45, s75
    s_cbranch_scc0 L_pb
    ds_read_b64 v[72:73], v23 offset:0
    ds_read_b64 v[74:75], v23 offset:256
    ds_read_b64 v[76:77], v23 offset:512
    ds_read_b64 v[78:79], v23 offset:768
    s_waitcnt lgkmcnt(0)
    v_add_f32 v72, v72, v74
    v_add_f32 v74, v73, v75
    v_add_f32 v76, v76, v78
    v_add_f32 v77, v77, v79
    v_add_f32 v72, v72, v76
    v_add_f32 v74, v74, v77
    v_mov_b32 v73, s55
    v_mov_b32 v75, s55
    s_mov_b32 exec_lo, 0x00ff00ff
    s_mov_b32 exec_hi, 0x00ff00ff
    buffer_store_dwordx4 v[72:75], v80, s[24:27], s71 offen sc1
    s_mov_b64 exec, -1
L_pb:
    s_waitcnt vmcnt(12)
    s_barrier
    s_add_u32 m0, s64, 49152
    s_add_u32 s63, s62, 512
    buffer_load_dwordx4 v11, s[28:31], s63 offen offset:0 lds
    s_and_b32 s58, s2, 7
    s_lshr_b32 s59, s2, 3
    s_and_b32 s60, s59, 3
    buffer_load_dwordx4 v12, s[28:31], s63 offen offset:1024 lds
    s_lshl_b32 s48, s58, 2
    s_add_u32 s48, s48, s60
    s_lshr_b32 s49, s59, 2
    buffer_load_dwordx4 v13, s[28:31], s63 offen offset:2048 lds
    s_and_b32 s54, s48, 1
    s_lshr_b32 s60, s48, 1
    s_mul_i32 s60, s60, 5
    buffer_load_dwordx4 v14, s[28:31], s63 offen offset:3072 lds
    s_add_u32 s53, s60, 2
    s_mul_i32 s61, s54, 3
    s_add_u32 s52, s60, s61
    s_add_u32 m0, s64, 65536
    s_add_u32 s63, s65, 983040
    buffer_load_dwordx4 v15, s[32:35], s63 offen offset:0 lds
    s_lshl_b32 s52, s52, 15
    s_lshl_b32 s53, s53, 15
    v_and_b32 v2, 31, v1
    buffer_load_dwordx4 v16, s[32:35], s63 offen offset:1024 lds
    v_lshrrev_b32 v3, 5, v1
    v_bfe_u32 v5, v2, 2, 1
    v_bfe_u32 v6, v2, 3, 2
    buffer_load_dwordx4 v17, s[32:35], s63 offen offset:2048 lds
    v_lshl_add_u32 v5, v5, 2, v6
    v_and_b32 v6, 3, v2
    v_lshl_add_u32 v4, v5, 2, v6
    buffer_load_dwordx4 v18, s[32:35], s63 offen offset:3072 lds
    v_lshlrev_b32 v5, 4, v4
    v_lshl_add_u32 v8, v3, 15, v5
    v_add_u32 v8, s52, v8
    s_add_u32 m0, s64, 81920
    s_add_u32 s63, s68, 884736
    buffer_load_dwordx4 v19, s[40:43], s63 offen offset:0 lds
    v_lshl_add_u32 v9, v3, 9, v5
    v_add_u32 v9, s53, v9
    v_cmp_le_u32 vcc, 20, v1
    buffer_load_dwordx4 v20, s[40:43], s63 offen offset:1024 lds
    s_lshl_b32 s58, s45, 10
    s_andn2_b32 s74, 1, s2
    s_mul_i32 s74, s74, 0
    buffer_load_dwordx4 v21, s[40:43], s63 offen offset:2048 lds
    buffer_load_dwordx4 v22, s[40:43], s63 offen offset:3072 lds
    s_waitcnt vmcnt(12)
    s_barrier
    s_add_u32 m0, s64, 98304
    s_sub_u32 s63, 640, s62
    buffer_load_dwordx4 v11, s[28:31], s63 offen offset:0 lds
    v_cndmask_b32 v4, 0, 1, vcc
    v_mul_u32_u24 v5, 20, v4
    v_sub_u32 v5, v1, v5
    buffer_load_dwordx4 v12, s[28:31], s63 offen offset:1024 lds
    v_mul_u32_u24 v10, 10240, v4
    v_lshrrev_b32 v6, 1, v5
    v_xor_b32 v6, v6, v5
    buffer_load_dwordx4 v13, s[28:31], s63 offen offset:2048 lds
    v_and_b32 v6, 4, v6
    v_lshlrev_b32 v7, 1, v6
    v_or_b32 v6, v6, v7
    buffer_load_dwordx4 v14, s[28:31], s63 offen offset:3072 lds
    v_xor_b32 v4, v6, v5
    s_lshl_b32 s58, s54, 2
    s_mul_i32 s59, s54, -16
    s_add_u32 m0, s64, 114688
    s_sub_u32 s63, 1228800, s65
    buffer_load_dwordx4 v15, s[32:35], s63 offen offset:0 lds
    v_cmp_gt_u32 vcc, 16, v5
    v_add_u32 v4, s58, v4
    v_add_u32 v6, s59, v5
    buffer_load_dwordx4 v16, s[32:35], s63 offen offset:1024 lds
    v_cndmask_b32 v4, v6, v4, vcc
    s_mul_i32 s58, s48, 320
    v_lshl_add_u32 v10, v4, 4, v10
    buffer_load_dwordx4 v17, s[32:35], s63 offen offset:2048 lds
    v_add_u32 v10, s58, v10
    v_min_u32 v253, 47, v1
    v_lshrrev_b32 v5, 4, v253
    buffer_load_dwordx4 v18, s[32:35], s63 offen offset:3072 lds
    v_and_b32 v253, 15, v253
    v_mul_u32_u24 v5, 22784, v5
    v_mul_u32_u24 v253, 656, v253
    s_add_u32 m0, s64, 131072
    s_sub_u32 s63, 1105920, s68
    buffer_load_dwordx4 v19, s[40:43], s63 offen offset:0 lds
    v_add_u32 v253, v253, v5
    v_add_u32 v253, 108416, v253
    v_and_b32 v2, 1, v1
    buffer_load_dwordx4 v20, s[40:43], s63 offen offset:1024 lds
    s_mul_i32 s58, s48, 20
    v_mad_u32_u24 v3, v2, 19, s58
    v_lshrrev_b32 v3, 6, v3
    buffer_load_dwordx4 v21, s[40:43], s63 offen offset:2048 lds
    buffer_load_dwordx4 v22, s[40:43], s63 offen offset:3072 lds
    s_cmp_lt_u32 s45, 2
    s_cbranch_scc0 L_gf
    s_mov_b32 s57, 20594688
    buffer_load_dwordx4 v[112:115], v24, s[24:27], s57 offen sc1
    s_mov_b32 s57, 20627456
    buffer_load_dwordx4 v[96:99], v26, s[24:27], s57 offen sc1
    s_add_u32 s57, s57, 29184
    buffer_load_dwordx4 v[100:103], v26, s[24:27], s57 offen sc1
    s_add_u32 s57, s57, 29184
    buffer_load_dwordx4 v[104:107], v26, s[24:27], s57 offen sc1
    s_add_u32 s57, s57, 29184
    buffer_load_dwordx4 v[108:111], v26, s[24:27], s57 offen sc1
    s_add_u32 s57, s57, 29184
L_gf:
    s_cmp_lt_u32 s45, 2
    s_cbranch_scc1 L_bw3
    s_waitcnt vmcnt(12)
L_bw3:
    s_waitcnt vmcnt(17)
    s_barrier
    s_add_u32 m0, s64, 0
    s_sub_u32 s63, 768, s62
    buffer_load_dwordx4 v11, s[28:31], s63 offen offset:0 lds
    v_lshrrev_b32 v2, 1, v1
    v_min_u32 v2, 2, v2
    v_mad_u32_u24 v3, v2, 10, v3
    buffer_load_dwordx4 v12, s[28:31], s63 offen offset:1024 lds
    v_mov_b32 v4, s74
    s_mov_b64 exec, 3
    v_mov_b32 v4, s49
    s_mov_b64 exec, -1
    v_lshl_add_u32 v4, v4, 2, s45
    buffer_load_dwordx4 v13, s[28:31], s63 offen offset:2048 lds
    v_lshl_add_u32 v252, v3, 5, v4
    v_lshlrev_b32 v252, 7, v252
    v_and_b32 v2, 1, v1
    buffer_load_dwordx4 v14, s[28:31], s63 offen offset:3072 lds
    s_mul_i32 s58, s48, 20
    v_mad_u32_u24 v3, v2, 19, s58
    v_lshrrev_b32 v3, 6, v3
    s_add_u32 m0, s64, 16384
    s_sub_u32 s63, 1474560, s65
    buffer_load_dwordx4 v15, s[32:35], s63 offen offset:0 lds
    v_bfe_u32 v2, v1, 1, 1
    v_mad_u32_u24 v3, v2, 10, v3
    v_add_u32 v3, 10, v3
    buffer_load_dwordx4 v16, s[32:35], s63 offen offset:1024 lds
    v_and_b32 v2, 28, v1
    v_add_u32 v2, s45, v2
    v_lshl_add_u32 v251, v3, 5, v2
    buffer_load_dwordx4 v17, s[32:35], s63 offen offset:2048 lds
    v_lshlrev_b32 v251, 7, v251
    v_and_b32 v2, 31, v1
    v_lshrrev_b32 v3, 5, v1
    buffer_load_dwordx4 v18, s[32:35], s63 offen offset:3072 lds
    s_lshl_b32 s58, s49, 2
    s_add_u32 s58, s58, s45
    s_lshl_b32 s58, s58, 10
    s_add_u32 m0, s64, 32768
    s_sub_u32 s63, 1327104, s68
    buffer_load_dwordx4 v19, s[40:43], s63 offen offset:0 lds
    s_lshl_b32 s59, s54, 3
    s_add_u32 s60, s58, s59
    v_lshlrev_b32 v4, 4, v2
    buffer_load_dwordx4 v20, s[40:43], s63 offen offset:1024 lds
    v_lshl_add_u32 v247, v3, 15, v4
    v_add_u32 v247, s58, v247
    v_add_u32 v248, s60, v4
    buffer_load_dwordx4 v21, s[40:43], s63 offen offset:2048 lds
    buffer_load_dwordx4 v22, s[40:43], s63 offen offset:3072 lds
    s_cmp_lt_u32 s45, 2
    s_cbranch_scc1 L_bw4
    s_waitcnt vmcnt(12)
L_bw4:
    s_waitcnt vmcnt(17)
    s_barrier
    s_add_u32 m0, s64, 49152
    s_sub_u32 s63, 896, s62
    buffer_load_dwordx4 v11, s[28:31], s63 offen offset:0 lds
    v_lshl_add_u32 v249, v1, 4, s58
    s_lshl_b32 s58, s48, 2
    s_add_u32 s58, s58, s45
    buffer_load_dwordx4 v12, s[28:31], s63 offen offset:1024 lds
    v_and_b32 v4, 15, v1
    v_lshl_add_u32 v4, s58, 4, v4
    v_lshrrev_b32 v5, 4, v1
    buffer_load_dwordx4 v13, s[28:31], s63 offen offset:2048 lds
    v_lshlrev_b32 v254, 15, v5
    v_lshl_add_u32 v254, v4, 4, v254
    v_mul_u32_u24 v255, 1280, v4
    buffer_load_dwordx4 v14, s[28:31], s63 offen offset:3072 lds
    v_min_u32 v5, 26, v2
    v_lshl_add_u32 v246, v5, 5, s48
    v_lshl_add_u32 v5, v2, 2, s45
    s_add_u32 m0, s64, 65536
    s_sub_u32 s63, 1720320, s65
    buffer_load_dwordx4 v15, s[32:35], s63 offen offset:0 lds
    v_min_u32 v5, 53, v5
    v_subrev_u32 v6, 16, v2
    v_min_u32 v6, 4, v6
    buffer_load_dwordx4 v16, s[32:35], s63 offen offset:1024 lds
    v_lshl_add_u32 v6, v6, 2, s45
    s_lshl_b32 s58, s49, 7
    s_add_u32 s58, s58, 1024
    buffer_load_dwordx4 v17, s[32:35], s63 offen offset:2048 lds
    s_add_u32 s70, s58, s50
    s_add_u32 s59, s58, 54
    s_mov_b32 exec_lo, 0
    v_add_u32 v246, s58, v5
    s_mov_b32 exec_hi, 0xffff0000
    v_add_u32 v246, s59, v6
    s_mov_b32 exec_hi, 0xffffffff
    v_and_b32 v246, 15, v2
    v_add_u32 v246, 1024, v246
    s_mov_b64 exec, -1
    buffer_load_dwordx4 v18, s[32:35], s63 offen offset:3072 lds
    v_lshlrev_b32 v246, 7, v246
    s_lshr_b32 s58, s48, 2
    v_lshl_add_u32 v250, s58, 5, v2
    s_add_u32 m0, s64, 81920
    s_sub_u32 s63, 1548288, s68
    buffer_load_dwordx4 v19, s[40:43], s63 offen offset:0 lds
    s_andn2_b32 s58, s2, 8
    s_mov_b32 exec_lo, 0
    v_mov_b32 v250, s58
    s_cmp_eq_u32 s2, 0
    s_cselect_b64 exec, -1, 0
    v_lshl_add_u32 v250, s45, 6, v1
    s_mov_b64 exec, -1
    v_lshlrev_b32 v250, 7, v250
    buffer_load_dwordx4 v20, s[40:43], s63 offen offset:1024 lds
    buffer_load_dwordx4 v21, s[40:43], s63 offen offset:2048 lds
    buffer_load_dwordx4 v22, s[40:43], s63 offen offset:3072 lds
    s_waitcnt vmcnt(12)
    s_barrier
    s_add_u32 m0, s64, 98304
    s_sub_u32 s63, 1024, s62
    buffer_load_dwordx4 v11, s[28:31], s63 offen offset:0 lds
    buffer_load_dwordx4 v12, s[28:31], s63 offen offset:1024 lds
    buffer_load_dwordx4 v13, s[28:31], s63 offen offset:2048 lds
    buffer_load_dwordx4 v14, s[28:31], s63 offen offset:3072 lds
    s_add_u32 m0, s64, 114688
    s_sub_u32 s63, 1966080, s65
    buffer_load_dwordx4 v15, s[32:35], s63 offen offset:0 lds
    buffer_load_dwordx4 v16, s[32:35], s63 offen offset:1024 lds
    buffer_load_dwordx4 v17, s[32:35], s63 offen offset:2048 lds
    buffer_load_dwordx4 v18, s[32:35], s63 offen offset:3072 lds
    s_cmp_lt_u32 s45, 2
    s_cbranch_scc0 L_gp
    s_branch L_ga_chk
L_ga:
    s_mov_b32 s57, 20594688
    buffer_load_dwordx4 v[112:115], v24, s[24:27], s57 offen sc1
    s_mov_b32 s57, 20627456
    buffer_load_dwordx4 v[96:99], v26, s[24:27], s57 offen sc1
    s_add_u32 s57, s57, 29184
    buffer_load_dwordx4 v[100:103], v26, s[24:27], s57 offen sc1
    s_add_u32 s57, s57, 29184
    buffer_load_dwordx4 v[104:107], v26, s[24:27], s57 offen sc1
    s_add_u32 s57, s57, 29184
    buffer_load_dwordx4 v[108:111], v26, s[24:27], s57 offen sc1
    s_add_u32 s57, s57, 29184
    s_sub_u32 s69, s69, 1
    s_waitcnt vmcnt(0)
L_ga_chk:
    v_min_u32 v5, v97, v99
    v_max_u32 v6, v97, v99
    v_min3_u32 v5, v5, v101, v103
    v_max3_u32 v6, v6, v101, v103
    v_min3_u32 v5, v5, v105, v107
    v_max3_u32 v6, v6, v105, v107
    v_min3_u32 v5, v5, v109, v111
    v_max3_u32 v6, v6, v109, v111
    v_min3_u32 v5, v5, v113, v115
    v_max3_u32 v6, v6, v113, v115
    v_cmp_ne_u32 vcc, s55, v5
    v_cmp_ne_u32 s[60:61], s55, v6
    s_cmp_eq_u32 s69, 0
    s_cbranch_scc1 L_ga_done
    s_or_b64 vcc, vcc, s[60:61]
    s_cbranch_scc1 L_ga
L_ga_done:
    v_add_f32 v97, v98, v102
    v_add_f32 v96, v96, v100
    v_add_f32 v96, v96, v104
    v_add_f32 v97, v97, v106
    v_add_f32 v96, v96, v108
    v_add_f32 v97, v97, v110
    s_mov_b32 s58, 147456
    v_lshlrev_b32 v98, 16, v28
    v_and_b32 v99, 0xffff0000, v28
    v_lshl_add_u32 v5, v25, 2, s58
    v_lshl_add_u32 v6, v25, 3, s58
    v_lshl_add_u32 v7, v1, 3, s58
    ds_write2_b32 v5, v112, v114 offset0:0 offset1:128
    ds_write_b64 v6, v[96:97] offset:1024
    ds_write_b64 v7, v[98:99] offset:2048
    s_waitcnt lgkmcnt(0)
L_gp:
    s_waitcnt vmcnt(8)
    s_barrier
    s_add_u32 m0, s64, 0
    s_sub_u32 s63, 1152, s62
    buffer_load_dwordx4 v11, s[28:31], s63 offen offset:0 lds
    buffer_load_dwordx4 v12, s[28:31], s63 offen offset:1024 lds
    buffer_load_dwordx4 v13, s[28:31], s63 offen offset:2048 lds
    buffer_load_dwordx4 v14, s[28:31], s63 offen offset:3072 lds
    s_add_u32 m0, s64, 16384
    s_sub_u32 s63, 2211840, s65
    buffer_load_dwordx4 v15, s[32:35], s63 offen offset:0 lds
    buffer_load_dwordx4 v16, s[32:35], s63 offen offset:1024 lds
    buffer_load_dwordx4 v17, s[32:35], s63 offen offset:2048 lds
    buffer_load_dwordx4 v18, s[32:35], s63 offen offset:3072 lds
    s_waitcnt vmcnt(8)
    s_barrier
    s_add_u32 m0, s64, 131072
    s_sub_u32 s63, 1769472, s68
    buffer_load_dwordx4 v19, s[40:43], s63 offen offset:0 lds
    buffer_load_dwordx4 v20, s[40:43], s63 offen offset:1024 lds
    buffer_load_dwordx4 v21, s[40:43], s63 offen offset:2048 lds
    buffer_load_dwordx4 v22, s[40:43], s63 offen offset:3072 lds
    s_waitcnt vmcnt(4)
    s_barrier
    s_add_u32 m0, s64, 32768
    s_sub_u32 s63, 1990656, s68
    buffer_load_dwordx4 v19, s[40:43], s63 offen offset:0 lds
    buffer_load_dwordx4 v20, s[40:43], s63 offen offset:1024 lds
    buffer_load_dwordx4 v21, s[40:43], s63 offen offset:2048 lds
    buffer_load_dwordx4 v22, s[40:43], s63 offen offset:3072 lds
    s_barrier
    s_waitcnt vmcnt(0)
    s_barrier
    s_barrier
L_b_last:
    s_setprio 2
    v_mov_b32 v20, 0x3f803f80
    v_mov_b32 v21, 0x3f803f80
    v_mov_b32 v22, 0x3f803f80
    v_mov_b32 v23, 0x3f803f80
    ds_write_b128 v253, v[20:23]
    s_mov_b32 s58, 20744192
    s_mov_b32 s69, 131072
    s_branch L_wa_ld
L_wa:
    s_sleep 1
L_wa_ld:
    buffer_load_dword v5, v252, s[24:27], s58 offen sc1
    s_sub_u32 s69, s69, 1
    s_waitcnt vmcnt(0)
    v_mov_b32 v6, v5
    v_cmp_ne_u32 vcc, s55, v5
    v_cmp_ne_u32 s[60:61], s55, v6
    s_cmp_eq_u32 s69, 0
    s_cbranch_scc1 L_wa_done
    s_or_b64 vcc, vcc, s[60:61]
    s_cbranch_scc1 L_wa
L_wa_done:
    s_mul_i32 s58, s45, 3072
    s_add_u32 m0, s58, 16384
    s_nop 0
    buffer_load_dwordx4 v247, s[24:27], s52 offen sc1 lds
    s_add_u32 m0, s58, 16896
    s_nop 0
    buffer_load_dwordx4 v247, s[24:27], s52 offen offset:512 sc1 lds
    s_add_u32 m0, s58, 18432
    s_nop 0
    buffer_load_dwordx4 v249, s[24:27], s53 offen sc1 lds
    s_and_b32 s58, s74, 7
    s_lshl_b32 s58, s58, 2
    s_add_u32 s58, s58, s45
    s_lshl_b32 s66, s58, 10
    s_add_u32 s66, s66, 2621440
    s_mul_i32 s67, s58, 81920
    s_add_u32 s67, s67, 14942208
    s_add_u32 s74, s74, 1
    s_lshl_b32 s58, s45, 11
    s_add_u32 m0, s58, 141056
    s_lshl_b32 s59, s45, 10
    buffer_load_dwordx4 v8, s[24:27], s66 offen sc1 lds
    s_add_u32 m0, s58, 141568
    s_mul_i32 s58, s45, 2624
    buffer_load_dwordx4 v8, s[24:27], s66 offen offset:512 sc1 lds
    s_add_u32 m0, s59, 149248
    s_nop 0
    buffer_load_dwordx4 v9, s[24:27], s66 offen sc1 lds
    s_mov_b32 exec_hi, 0xff
    s_add_u32 m0, s58, 153344
    s_add_u32 s59, s67, 0
    buffer_load_dwordx4 v10, s[24:27], s59 offen sc1 lds
    s_add_u32 m0, s58, 154000
    s_add_u32 s59, s67, 20480
    buffer_load_dwordx4 v10, s[24:27], s59 offen sc1 lds
    s_add_u32 m0, s58, 154656
    s_add_u32 s59, s67, 40960
    buffer_load_dwordx4 v10, s[24:27], s59 offen sc1 lds
    s_add_u32 m0, s58, 155312
    s_add_u32 s59, s67, 61440
    buffer_load_dwordx4 v10, s[24:27], s59 offen sc1 lds
    s_mov_b32 exec_hi, -1
    s_mov_b32 s58, 20744192
    buffer_load_dword v5, v251, s[24:27], s58 offen sc1
    s_barrier
    s_waitcnt vmcnt(1) lgkmcnt(0)
    s_barrier
    s_waitcnt vmcnt(0)
    v_cmp_ne_u32 vcc, s55, v5
    s_nop 3
    s_cbranch_vccz L_wk_done
    s_mov_b32 s58, 20744192
    s_mov_b32 s69, 131072
    s_branch L_wk_ld
L_wk:
    s_sleep 1
L_wk_ld:
    buffer_load_dword v5, v251, s[24:27], s58 offen sc1
    s_sub_u32 s69, s69, 1
    s_waitcnt vmcnt(0)
    v_mov_b32 v6, v5
    v_cmp_ne_u32 vcc, s55, v5
    v_cmp_ne_u32 s[60:61], s55, v6
    s_cmp_eq_u32 s69, 0
    s_cbranch_scc1 L_wk_done
    s_or_b64 vcc, vcc, s[60:61]
    s_cbranch_scc1 L_wk
L_wk_done:
    s_and_b32 s58, s74, 7
    s_lshl_b32 s58, s58, 2
    s_add_u32 s58, s58, s45
    s_lshl_b32 s66, s58, 10
    s_add_u32 s66, s66, 2621440
    s_mul_i32 s67, s58, 81920
    s_add_u32 s67, s67, 14942208
    s_add_u32 s74, s74, 1
    s_lshl_b32 s58, s45, 11
    s_add_u32 m0, s58, 95488
    s_lshl_b32 s59, s45, 10
    buffer_load_dwordx4 v8, s[24:27], s66 offen sc1 lds
    s_add_u32 m0, s58, 96000
    s_mul_i32 s58, s45, 2624
    buffer_load_dwordx4 v8, s[24:27], s66 offen offset:512 sc1 lds
    s_add_u32 m0, s59, 103680
    s_nop 0
    buffer_load_dwordx4 v9, s[24:27], s66 offen sc1 lds
    s_mov_b32 exec_hi, 0xff
    s_add_u32 m0, s58, 107776
    s_add_u32 s59, s67, 0
    buffer_load_dwordx4 v10, s[24:27], s59 offen sc1 lds
    s_add_u32 m0, s58, 108432
    s_add_u32 s59, s67, 20480
    buffer_load_dwordx4 v10, s[24:27], s59 offen sc1 lds
    s_add_u32 m0, s58, 109088
    s_add_u32 s59, s67, 40960
    buffer_load_dwordx4 v10, s[24:27], s59 offen sc1 lds
    s_add_u32 m0, s58, 109744
    s_add_u32 s59, s67, 61440
    buffer_load_dwordx4 v10, s[24:27], s59 offen sc1 lds
    s_mov_b32 exec_hi, -1
    v_mov_b32 v11, v254
    v_xor_b32 v12, 256, v254
    v_xor_b32 v13, 512, v254
    v_xor_b32 v14, 768, v254
    v_lshlrev_b32 v19, 4, v1
    s_mul_i32 s58, s49, 5120
    v_add_u32 v15, s58, v19
    v_add_u32 v16, 4096, v15
    s_mul_i32 s58, s49, 160
    v_lshrrev_b32 v4, 4, v1
    v_lshl_add_u32 v2, v4, 4, s58
    v_lshl_add_u32 v3, v4, 3, s58
    v_add_u32 v17, v255, v2
    v_add_u32 v18, v255, v3
    s_add_u32 s32, s22, 5242880
    s_addc_u32 s33, s23, 0
    s_mov_b32 s34, 7077888
    s_mov_b32 s35, 0x00020000
    s_add_u32 s36, s22, 17563648
    s_addc_u32 s37, s23, 0
    s_mov_b32 s38, 2211840
    s_mov_b32 s39, 0x00020000
    s_lshl_b32 s68, s45, 17
    s_mul_i32 s63, s45, 40960
    s_add_u32 s62, s63, 19775488
    s_mul_i32 s64, s45, 5120
    s_waitcnt vmcnt(0)
    s_and_b32 s58, s74, 7
    s_lshl_b32 s58, s58, 2
    s_add_u32 s58, s58, s45
    s_lshl_b32 s66, s58, 10
    s_add_u32 s66, s66, 2621440
    s_mul_i32 s67, s58, 81920
    s_add_u32 s67, s67, 14942208
    s_add_u32 s74, s74, 1
    s_lshl_b32 s58, s45, 11
    s_add_u32 m0, s58, 118272
    s_lshl_b32 s59, s45, 10
    buffer_load_dwordx4 v8, s[24:27], s66 offen sc1 lds
    s_add_u32 m0, s58, 118784
    s_mul_i32 s58, s45, 2624
    buffer_load_dwordx4 v8, s[24:27], s66 offen offset:512 sc1 lds
    s_add_u32 m0, s59, 126464
    s_nop 0
    buffer_load_dwordx4 v9, s[24:27], s66 offen sc1 lds
    s_mov_b32 exec_hi, 0xff
    s_add_u32 m0, s58, 130560
    s_add_u32 s59, s67, 0
    buffer_load_dwordx4 v10, s[24:27], s59 offen sc1 lds
    s_add_u32 m0, s58, 131216
    s_add_u32 s59, s67, 20480
    buffer_load_dwordx4 v10, s[24:27], s59 offen sc1 lds
    s_add_u32 m0, s58, 131872
    s_add_u32 s59, s67, 40960
    buffer_load_dwordx4 v10, s[24:27], s59 offen sc1 lds
    s_add_u32 m0, s58, 132528
    s_add_u32 s59, s67, 61440
    buffer_load_dwordx4 v10, s[24:27], s59 offen sc1 lds
    s_mov_b32 exec_hi, -1
    s_barrier
    s_mov_b32 s70, s2
    s_mov_b32 s58, 20875264
    s_mov_b32 s69, 3
    s_branch L_wb_ld
L_wb:
    s_sleep 1
L_wb_ld:
    buffer_load_dword v5, v246, s[24:27], s58 offen sc1
    s_sub_u32 s69, s69, 1
    s_waitcnt vmcnt(0)
    v_mov_b32 v6, v5
    v_cmp_ne_u32 vcc, s55, v5
    v_cmp_ne_u32 s[60:61], s55, v6
    s_cmp_eq_u32 s69, 0
    s_cbranch_scc1 L_wb_done
    s_or_b64 vcc, vcc, s[60:61]
    s_cbranch_scc1 L_wb
L_wb_done:
    s_mov_b32 s57, s69
    s_cbranch_vccz L_fb_go
    s_barrier
    s_mov_b32 s58, 20875264
    s_mov_b32 s69, 131072
    s_branch L_wc_ld
L_wc:
    s_sleep 1
L_wc_ld:
    buffer_load_dword v5, v246, s[24:27], s58 offen sc1
    s_sub_u32 s69, s69, 1
    s_waitcnt vmcnt(0)
    v_mov_b32 v6, v5
    v_cmp_ne_u32 vcc, s55, v5
    v_cmp_ne_u32 s[60:61], s55, v6
    s_cmp_eq_u32 s69, 0
    s_cbranch_scc1 L_wc_done
    s_or_b64 vcc, vcc, s[60:61]
    s_cbranch_scc1 L_wc
L_wc_done:
    s_mov_b32 s57, -1
L_fb_go:
    buffer_load_dwordx4 v[100:103], v11, s[32:35], s68 offen sc1
    buffer_load_dwordx4 v[104:107], v12, s[32:35], s68 offen sc1
    buffer_load_dwordx4 v[108:111], v13, s[32:35], s68 offen sc1
    buffer_load_dwordx4 v[112:115], v14, s[32:35], s68 offen sc1
    buffer_load_dwordx4 v[116:119], v15, s[36:39], s63 offen offset:0 sc1
    buffer_load_dwordx4 v[120:123], v15, s[36:39], s63 offen offset:1024 sc1
    buffer_load_dwordx4 v[124:127], v15, s[36:39], s63 offen offset:2048 sc1
    buffer_load_dwordx4 v[128:131], v15, s[36:39], s63 offen offset:3072 sc1
    buffer_load_dwordx4 v[132:135], v16, s[36:39], s63 offen offset:0 sc1
    s_add_u32 s68, s68, 524288
    s_add_u32 s63, s63, 163840
    s_cmp_eq_u32 s57, 0
    s_cbranch_scc0 L_fb1
    s_barrier
L_fb1:
    buffer_load_dwordx4 v[136:139], v11, s[32:35], s68 offen sc1
    buffer_load_dwordx4 v[140:143], v12, s[32:35], s68 offen sc1
    buffer_load_dwordx4 v[144:147], v13, s[32:35], s68 offen sc1
    buffer_load_dwordx4 v[148:151], v14, s[32:35], s68 offen sc1
    buffer_load_dwordx4 v[152:155], v15, s[36:39], s63 offen offset:0 sc1
    buffer_load_dwordx4 v[156:159], v15, s[36:39], s63 offen offset:1024 sc1
    buffer_load_dwordx4 v[160:163], v15, s[36:39], s63 offen offset:2048 sc1
    buffer_load_dwordx4 v[164:167], v15, s[36:39], s63 offen offset:3072 sc1
    buffer_load_dwordx4 v[168:171], v16, s[36:39], s63 offen offset:0 sc1
    s_add_u32 s68, s68, 524288
    s_add_u32 s63, s63, 163840
    s_add_u32 s66, s52, 12320768
    s_add_u32 s67, s53, 12320768
    v_mov_b64 v[240:241], -1
    v_mov_b64 v[242:243], -1
    buffer_store_dwordx4 v[240:243], v247, s[24:27], s66 offen sc1
    buffer_store_dwordx4 v[240:243], v247, s[24:27], s66 offen offset:512 sc1
    s_cmp_eq_u32 s54, 0
    s_cselect_b32 s67, s67, 21170304
    buffer_store_dwordx4 v[240:243], v249, s[24:27], s67 offen sc1
    s_cmp_gt_i32 s57, 0
    s_cbranch_scc0 L_fb2
    s_barrier
L_fb2:
    s_setprio 0
    s_waitcnt vmcnt(12)
    v_mfma_f32_16x16x32_bf16 v[20:23], v[116:119], v[100:103], 0
    s_and_b32 s58, s74, 7
    s_lshl_b32 s58, s58, 2
    s_add_u32 s58, s58, s45
    s_lshl_b32 s66, s58, 10
    s_add_u32 s66, s66, 2621440
    s_mul_i32 s67, s58, 81920
    s_add_u32 s67, s67, 14942208
    s_add_u32 s74, s74, 1
    s_lshl_b32 s58, s45, 11
    s_add_u32 m0, s58, 141056
    s_lshl_b32 s59, s45, 10
    buffer_load_dwordx4 v8, s[24:27], s66 offen sc1 lds
    v_mfma_f32_16x16x32_bf16 v[24:27], v[120:123], v[100:103], 0
    buffer_load_dwordx4 v[172:175], v11, s[32:35], s68 offen sc1
    v_mfma_f32_16x16x32_bf16 v[28:31], v[124:127], v[100:103], 0
    s_add_u32 m0, s58, 141568
    s_mul_i32 s58, s45, 2624
    buffer_load_dwordx4 v8, s[24:27], s66 offen offset:512 sc1 lds
    v_mfma_f32_16x16x32_bf16 v[32:35], v[128:131], v[100:103], 0
    buffer_load_dwordx4 v[176:179], v12, s[32:35], s68 offen sc1
    v_mfma_f32_16x16x32_bf16 v[36:39], v[132:135], v[100:103], 0
    s_add_u32 m0, s59, 149248
    s_nop 0
    buffer_load_dwordx4 v9, s[24:27], s66 offen sc1 lds
    v_mfma_f32_16x16x32_bf16 v[40:43], v[116:119], v[104:107], 0
    buffer_load_dwordx4 v[180:183], v13, s[32:35], s68 offen sc1
    v_mfma_f32_16x16x32_bf16 v[44:47], v[120:123], v[104:107], 0
    s_mov_b32 exec_hi, 0xff
    s_add_u32 m0, s58, 153344
    s_add_u32 s59, s67, 0
    buffer_load_dwordx4 v10, s[24:27], s59 offen sc1 lds
    s_add_u32 m0, s58, 154000
    s_add_u32 s59, s67, 20480
    buffer_load_dwordx4 v10, s[24:27], s59 offen sc1 lds
    s_add_u32 m0, s58, 154656
    s_add_u32 s59, s67, 40960
    buffer_load_dwordx4 v10, s[24:27], s59 offen sc1 lds
    s_add_u32 m0, s58, 155312
    s_add_u32 s59, s67, 61440
    buffer_load_dwordx4 v10, s[24:27], s59 offen sc1 lds
    s_mov_b32 exec_hi, -1
    v_mfma_f32_16x16x32_bf16 v[48:51], v[124:127], v[104:107], 0
    buffer_load_dwordx4 v[184:187], v14, s[32:35], s68 offen sc1
    v_mfma_f32_16x16x32_bf16 v[52:55], v[128:131], v[104:107], 0
    buffer_load_dwordx4 v[188:191], v15, s[36:39], s63 offen offset:0 sc1
    v_mfma_f32_16x16x32_bf16 v[56:59], v[132:135], v[104:107], 0
    buffer_load_dwordx4 v[192:195], v15, s[36:39], s63 offen offset:1024 sc1
    v_mfma_f32_16x16x32_bf16 v[60:63], v[116:119], v[108:111], 0
    buffer_load_dwordx4 v[196:199], v15, s[36:39], s63 offen offset:2048 sc1
    v_mfma_f32_16x16x32_bf16 v[64:67], v[120:123], v[108:111], 0
    buffer_load_dwordx4 v[200:203], v15, s[36:39], s63 offen offset:3072 sc1
    v_mfma_f32_16x16x32_bf16 v[68:71], v[124:127], v[108:111], 0
    buffer_load_dwordx4 v[204:207], v16, s[36:39], s63 offen offset:0 sc1
    s_add_u32 s68, s68, 524288
    s_add_u32 s63, s63, 163840
    v_mfma_f32_16x16x32_bf16 v[72:75], v[128:131], v[108:111], 0
    v_mfma_f32_16x16x32_bf16 v[76:79], v[132:135], v[108:111], 0
    v_mfma_f32_16x16x32_bf16 v[80:83], v[116:119], v[112:115], 0
    v_mfma_f32_16x16x32_bf16 v[84:87], v[120:123], v[112:115], 0
    v_mfma_f32_16x16x32_bf16 v[88:91], v[124:127], v[112:115], 0
    v_mfma_f32_16x16x32_bf16 v[92:95], v[128:131], v[112:115], 0
    v_mfma_f32_16x16x32_bf16 v[96:99], v[132:135], v[112:115], 0
    s_waitcnt vmcnt(19)
    v_mfma_f32_16x16x32_bf16 v[20:23], v[152:155], v[136:139], v[20:23]
    buffer_load_dwordx4 v[100:103], v11, s[32:35], s68 offen sc1
    v_mfma_f32_16x16x32_bf16 v[24:27], v[156:159], v[136:139], v[24:27]
    buffer_load_dwordx4 v[104:107], v12, s[32:35], s68 offen sc1
    v_mfma_f32_16x16x32_bf16 v[28:31], v[160:163], v[136:139], v[28:31]
    buffer_load_dwordx4 v[108:111], v13, s[32:35], s68 offen sc1
    v_mfma_f32_16x16x32_bf16 v[32:35], v[164:167], v[136:139], v[32:35]
    buffer_load_dwordx4 v[112:115], v14, s[32:35], s68 offen sc1
    v_mfma_f32_16x16x32_bf16 v[36:39], v[168:171], v[136:139], v[36:39]
    buffer_load_dwordx4 v[116:119], v15, s[36:39], s63 offen offset:0 sc1
    v_mfma_f32_16x16x32_bf16 v[40:43], v[152:155], v[140:143], v[40:43]
    buffer_load_dwordx4 v[120:123], v15, s[36:39], s63 offen offset:1024 sc1
    v_mfma_f32_16x16x32_bf16 v[44:47], v[156:159], v[140:143], v[44:47]
    buffer_load_dwordx4 v[124:127], v15, s[36:39], s63 offen offset:2048 sc1
    v_mfma_f32_16x16x32_bf16 v[48:51], v[160:163], v[140:143], v[48:51]
    buffer_load_dwordx4 v[128:131], v15, s[36:39], s63 offen offset:3072 sc1
    v_mfma_f32_16x16x32_bf16 v[52:55], v[164:167], v[140:143], v[52:55]
    buffer_load_dwordx4 v[132:135], v16, s[36:39], s63 offen offset:0 sc1
    s_add_u32 s68, s68, 524288
    s_add_u32 s63, s63, 163840
    v_mfma_f32_16x16x32_bf16 v[56:59], v[168:171], v[140:143], v[56:59]
    v_mfma_f32_16x16x32_bf16 v[60:63], v[152:155], v[144:147], v[60:63]
    v_mfma_f32_16x16x32_bf16 v[64:67], v[156:159], v[144:147], v[64:67]
    v_mfma_f32_16x16x32_bf16 v[68:71], v[160:163], v[144:147], v[68:71]
    v_mfma_f32_16x16x32_bf16 v[72:75], v[164:167], v[144:147], v[72:75]
    v_mfma_f32_16x16x32_bf16 v[76:79], v[168:171], v[144:147], v[76:79]
    v_mfma_f32_16x16x32_bf16 v[80:83], v[152:155], v[148:151], v[80:83]
    v_mfma_f32_16x16x32_bf16 v[84:87], v[156:159], v[148:151], v[84:87]
    v_mfma_f32_16x16x32_bf16 v[88:91], v[160:163], v[148:151], v[88:91]
    v_mfma_f32_16x16x32_bf16 v[92:95], v[164:167], v[148:151], v[92:95]
    v_mfma_f32_16x16x32_bf16 v[96:99], v[168:171], v[148:151], v[96:99]
    s_waitcnt vmcnt(9)
    v_mfma_f32_16x16x32_bf16 v[20:23], v[188:191], v[172:175], v[20:23]
    buffer_load_dwordx4 v[136:139], v11, s[32:35], s68 offen sc1
    v_mfma_f32_16x16x32_bf16 v[24:27], v[192:195], v[172:175], v[24:27]
    buffer_load_dwordx4 v[140:143], v12, s[32:35], s68 offen sc1
    v_mfma_f32_16x16x32_bf16 v[28:31], v[196:199], v[172:175], v[28:31]
    buffer_load_dwordx4 v[144:147], v13, s[32:35], s68 offen sc1
    v_mfma_f32_16x16x32_bf16 v[32:35], v[200:203], v[172:175], v[32:35]
    buffer_load_dwordx4 v[148:151], v14, s[32:35], s68 offen sc1
    v_mfma_f32_16x16x32_bf16 v[36:39], v[204:207], v[172:175], v[36:39]
    buffer_load_dwordx4 v[152:155], v15, s[36:39], s63 offen offset:0 sc1
    v_mfma_f32_16x16x32_bf16 v[40:43], v[188:191], v[176:179], v[40:43]
    buffer_load_dwordx4 v[156:159], v15, s[36:39], s63 offen offset:1024 sc1
    s_barrier
    s_cmp_eq_u32 s45, 0
    s_cbranch_scc0 L_fb
    s_lshl_b32 s58, s70, 7
    s_add_u32 s58, s58, 21137408
    v_lshlrev_b32 v6, 2, v1
    v_mov_b32 v5, s55
    s_mov_b32 exec_hi, 0
    buffer_store_dword v5, v6, s[24:27], s58 offen sc1
    s_mov_b64 exec, -1
L_fb:
    v_mfma_f32_16x16x32_bf16 v[44:47], v[192:195], v[176:179], v[44:47]
    s_and_b32 s58, s74, 7
    s_lshl_b32 s58, s58, 2
    s_add_u32 s58, s58, s45
    s_lshl_b32 s66, s58, 10
    s_add_u32 s66, s66, 2621440
    s_mul_i32 s67, s58, 81920
    s_add_u32 s67, s67, 14942208
    s_add_u32 s74, s74, 1
    s_lshl_b32 s58, s45, 11
    s_add_u32 m0, s58, 95488
    s_lshl_b32 s59, s45, 10
    buffer_load_dwordx4 v8, s[24:27], s66 offen sc1 lds
    v_mfma_f32_16x16x32_bf16 v[48:51], v[196:199], v[176:179], v[48:51]
    buffer_load_dwordx4 v[160:163], v15, s[36:39], s63 offen offset:2048 sc1
    v_mfma_f32_16x16x32_bf16 v[52:55], v[200:203], v[176:179], v[52:55]
    s_add_u32 m0, s58, 96000
    s_mul_i32 s58, s45, 2624
    buffer_load_dwordx4 v8, s[24:27], s66 offen offset:512 sc1 lds
    v_mfma_f32_16x16x32_bf16 v[56:59], v[204:207], v[176:179], v[56:59]
    buffer_load_dwordx4 v[164:167], v15, s[36:39], s63 offen offset:3072 sc1
    v_mfma_f32_16x16x32_bf16 v[60:63], v[188:191], v[180:183], v[60:63]
    s_add_u32 m0, s59, 103680
    s_nop 0
    buffer_load_dwordx4 v9, s[24:27], s66 offen sc1 lds
    v_mfma_f32_16x16x32_bf16 v[64:67], v[192:195], v[180:183], v[64:67]
    buffer_load_dwordx4 v[168:171], v16, s[36:39], s63 offen offset:0 sc1
    s_add_u32 s68, s68, 524288
    s_add_u32 s63, s63, 163840
    v_mfma_f32_16x16x32_bf16 v[68:71], v[196:199], v[180:183], v[68:71]
    s_mov_b32 exec_hi, 0xff
    s_add_u32 m0, s58, 107776
    s_add_u32 s59, s67, 0
    buffer_load_dwordx4 v10, s[24:27], s59 offen sc1 lds
    s_add_u32 m0, s58, 108432
    s_add_u32 s59, s67, 20480
    buffer_load_dwordx4 v10, s[24:27], s59 offen sc1 lds
    s_add_u32 m0, s58, 109088
    s_add_u32 s59, s67, 40960
    buffer_load_dwordx4 v10, s[24:27], s59 offen sc1 lds
    s_add_u32 m0, s58, 109744
    s_add_u32 s59, s67, 61440
    buffer_load_dwordx4 v10, s[24:27], s59 offen sc1 lds
    s_mov_b32 exec_hi, -1
    v_mfma_f32_16x16x32_bf16 v[72:75], v[200:203], v[180:183], v[72:75]
    v_mfma_f32_16x16x32_bf16 v[76:79], v[204:207], v[180:183], v[76:79]
    v_mfma_f32_16x16x32_bf16 v[80:83], v[188:191], v[184:187], v[80:83]
    v_mfma_f32_16x16x32_bf16 v[84:87], v[192:195], v[184:187], v[84:87]
    v_mfma_f32_16x16x32_bf16 v[88:91], v[196:199], v[184:187], v[88:91]
    v_mfma_f32_16x16x32_bf16 v[92:95], v[200:203], v[184:187], v[92:95]
    v_mfma_f32_16x16x32_bf16 v[96:99], v[204:207], v[184:187], v[96:99]
    s_waitcnt vmcnt(16)
    v_mfma_f32_16x16x32_bf16 v[20:23], v[116:119], v[100:103], v[20:23]
    buffer_load_dwordx4 v[172:175], v11, s[32:35], s68 offen sc1
    v_mfma_f32_16x16x32_bf16 v[24:27], v[120:123], v[100:103], v[24:27]
    buffer_load_dwordx4 v[176:179], v12, s[32:35], s68 offen sc1
    v_mfma_f32_16x16x32_bf16 v[28:31], v[124:127], v[100:103], v[28:31]
    buffer_load_dwordx4 v[180:183], v13, s[32:35], s68 offen sc1
    v_mfma_f32_16x16x32_bf16 v[32:35], v[128:131], v[100:103], v[32:35]
    buffer_load_dwordx4 v[184:187], v14, s[32:35], s68 offen sc1
    v_mfma_f32_16x16x32_bf16 v[36:39], v[132:135], v[100:103], v[36:39]
    buffer_load_dwordx4 v[188:191], v15, s[36:39], s63 offen offset:0 sc1
    v_mfma_f32_16x16x32_bf16 v[40:43], v[116:119], v[104:107], v[40:43]
    buffer_load_dwordx4 v[192:195], v15, s[36:39], s63 offen offset:1024 sc1
    v_mfma_f32_16x16x32_bf16 v[44:47], v[120:123], v[104:107], v[44:47]
    buffer_load_dwordx4 v[196:199], v15, s[36:39], s63 offen offset:2048 sc1
    v_mfma_f32_16x16x32_bf16 v[48:51], v[124:127], v[104:107], v[48:51]
    buffer_load_dwordx4 v[200:203], v15, s[36:39], s63 offen offset:3072 sc1
    v_mfma_f32_16x16x32_bf16 v[52:55], v[128:131], v[104:107], v[52:55]
    buffer_load_dwordx4 v[204:207], v16, s[36:39], s63 offen offset:0 sc1
    s_add_u32 s68, s68, 524288
    s_add_u32 s63, s63, 163840
    v_mfma_f32_16x16x32_bf16 v[56:59], v[132:135], v[104:107], v[56:59]
    v_mfma_f32_16x16x32_bf16 v[60:63], v[116:119], v[108:111], v[60:63]
    v_mfma_f32_16x16x32_bf16 v[64:67], v[120:123], v[108:111], v[64:67]
    v_mfma_f32_16x16x32_bf16 v[68:71], v[124:127], v[108:111], v[68:71]
    v_mfma_f32_16x16x32_bf16 v[72:75], v[128:131], v[108:111], v[72:75]
    v_mfma_f32_16x16x32_bf16 v[76:79], v[132:135], v[108:111], v[76:79]
    v_mfma_f32_16x16x32_bf16 v[80:83], v[116:119], v[112:115], v[80:83]
    v_mfma_f32_16x16x32_bf16 v[84:87], v[120:123], v[112:115], v[84:87]
    v_mfma_f32_16x16x32_bf16 v[88:91], v[124:127], v[112:115], v[88:91]
    v_mfma_f32_16x16x32_bf16 v[92:95], v[128:131], v[112:115], v[92:95]
    v_mfma_f32_16x16x32_bf16 v[96:99], v[132:135], v[112:115], v[96:99]
    s_waitcnt vmcnt(13)
    v_mfma_f32_16x16x32_bf16 v[20:23], v[152:155], v[136:139], v[20:23]
    buffer_load_dwordx4 v[100:103], v11, s[32:35], s68 offen sc1
    v_mfma_f32_16x16x32_bf16 v[24:27], v[156:159], v[136:139], v[24:27]
    buffer_load_dwordx4 v[104:107], v12, s[32:35], s68 offen sc1
    v_mfma_f32_16x16x32_bf16 v[28:31], v[160:163], v[136:139], v[28:31]
    buffer_load_dwordx4 v[108:111], v13, s[32:35], s68 offen sc1
    v_mfma_f32_16x16x32_bf16 v[32:35], v[164:167], v[136:139], v[32:35]
    buffer_load_dwordx4 v[112:115], v14, s[32:35], s68 offen sc1
    v_mfma_f32_16x16x32_bf16 v[36:39], v[168:171], v[136:139], v[36:39]
    buffer_load_dwordx4 v[116:119], v15, s[36:39], s63 offen offset:0 sc1
    v_mfma_f32_16x16x32_bf16 v[40:43], v[152:155], v[140:143], v[40:43]
    buffer_load_dwordx4 v[120:123], v15, s[36:39], s63 offen offset:1024 sc1
    v_mfma_f32_16x16x32_bf16 v[44:47], v[156:159], v[140:143], v[44:47]
    buffer_load_dwordx4 v[124:127], v15, s[36:39], s63 offen offset:2048 sc1
    v_mfma_f32_16x16x32_bf16 v[48:51], v[160:163], v[140:143], v[48:51]
    buffer_load_dwordx4 v[128:131], v15, s[36:39], s63 offen offset:3072 sc1
    v_mfma_f32_16x16x32_bf16 v[52:55], v[164:167], v[140:143], v[52:55]
    buffer_load_dwordx4 v[132:135], v16, s[36:39], s63 offen offset:0 sc1
    s_add_u32 s68, s68, 524288
    s_add_u32 s63, s63, 163840
    v_mfma_f32_16x16x32_bf16 v[56:59], v[168:171], v[140:143], v[56:59]
    v_mfma_f32_16x16x32_bf16 v[60:63], v[152:155], v[144:147], v[60:63]
    v_mfma_f32_16x16x32_bf16 v[64:67], v[156:159], v[144:147], v[64:67]
    v_mfma_f32_16x16x32_bf16 v[68:71], v[160:163], v[144:147], v[68:71]
    v_mfma_f32_16x16x32_bf16 v[72:75], v[164:167], v[144:147], v[72:75]
    v_mfma_f32_16x16x32_bf16 v[76:79], v[168:171], v[144:147], v[76:79]
    s_waitcnt vmcnt(18)
    s_barrier
    v_mfma_f32_16x16x32_bf16 v[80:83], v[152:155], v[148:151], v[80:83]
    s_and_b32 s58, s74, 7
    s_lshl_b32 s58, s58, 2
    s_add_u32 s58, s58, s45
    s_lshl_b32 s66, s58, 10
    s_add_u32 s66, s66, 2621440
    s_mul_i32 s67, s58, 81920
    s_add_u32 s67, s67, 14942208
    s_add_u32 s74, s74, 1
    s_lshl_b32 s58, s45, 11
    s_add_u32 m0, s58, 118272
    s_lshl_b32 s59, s45, 10
    buffer_load_dwordx4 v8, s[24:27], s66 offen sc1 lds
    v_mfma_f32_16x16x32_bf16 v[84:87], v[156:159], v[148:151], v[84:87]
    s_add_u32 m0, s58, 118784
    s_mul_i32 s58, s45, 2624
    buffer_load_dwordx4 v8, s[24:27], s66 offen offset:512 sc1 lds
    v_mfma_f32_16x16x32_bf16 v[88:91], v[160:163], v[148:151], v[88:91]
    s_add_u32 m0, s59, 126464
    s_nop 0
    buffer_load_dwordx4 v9, s[24:27], s66 offen sc1 lds
    v_mfma_f32_16x16x32_bf16 v[92:95], v[164:167], v[148:151], v[92:95]
    s_mov_b32 exec_hi, 0xff
    s_add_u32 m0, s58, 130560
    s_add_u32 s59, s67, 0
    buffer_load_dwordx4 v10, s[24:27], s59 offen sc1 lds
    s_add_u32 m0, s58, 131216
    s_add_u32 s59, s67, 20480
    buffer_load_dwordx4 v10, s[24:27], s59 offen sc1 lds
    s_add_u32 m0, s58, 131872
    s_add_u32 s59, s67, 40960
    buffer_load_dwordx4 v10, s[24:27], s59 offen sc1 lds
    s_add_u32 m0, s58, 132528
    s_add_u32 s59, s67, 61440
    buffer_load_dwordx4 v10, s[24:27], s59 offen sc1 lds
    s_mov_b32 exec_hi, -1
    v_mfma_f32_16x16x32_bf16 v[96:99], v[168:171], v[148:151], v[96:99]
    s_add_u32 m0, s64, 0
    s_nop 0
    buffer_load_dwordx4 v15, s[24:27], s62 offen offset:0 sc1 lds
    s_waitcnt vmcnt(17)
    v_mfma_f32_16x16x32_bf16 v[20:23], v[188:191], v[172:175], v[20:23]
    buffer_load_dwordx4 v15, s[24:27], s62 offen offset:1024 sc1 lds
    v_mfma_f32_16x16x32_bf16 v[24:27], v[192:195], v[172:175], v[24:27]
    buffer_load_dwordx4 v[136:139], v11, s[32:35], s68 offen sc1
    v_mfma_f32_16x16x32_bf16 v[28:31], v[196:199], v[172:175], v[28:31]
    buffer_load_dwordx4 v15, s[24:27], s62 offen offset:2048 sc1 lds
    v_mfma_f32_16x16x32_bf16 v[32:35], v[200:203], v[172:175], v[32:35]
    buffer_load_dwordx4 v[140:143], v12, s[32:35], s68 offen sc1
    v_mfma_f32_16x16x32_bf16 v[36:39], v[204:207], v[172:175], v[36:39]
    buffer_load_dwordx4 v15, s[24:27], s62 offen offset:3072 sc1 lds
    v_mfma_f32_16x16x32_bf16 v[40:43], v[188:191], v[176:179], v[40:43]
    buffer_load_dwordx4 v[144:147], v13, s[32:35], s68 offen sc1
    v_mfma_f32_16x16x32_bf16 v[44:47], v[192:195], v[176:179], v[44:47]
    s_add_u32 m0, s64, 4096
    s_nop 0
    buffer_load_dwordx4 v16, s[24:27], s62 offen offset:0 sc1 lds
    s_add_u32 s62, s62, 163840
    v_mfma_f32_16x16x32_bf16 v[48:51], v[196:199], v[176:179], v[48:51]
    buffer_load_dwordx4 v[148:151], v14, s[32:35], s68 offen sc1
    v_mfma_f32_16x16x32_bf16 v[52:55], v[200:203], v[176:179], v[52:55]
    buffer_load_dwordx4 v[152:155], v15, s[36:39], s63 offen offset:0 sc1
    v_mfma_f32_16x16x32_bf16 v[56:59], v[204:207], v[176:179], v[56:59]
    buffer_load_dwordx4 v[156:159], v15, s[36:39], s63 offen offset:1024 sc1
    v_mfma_f32_16x16x32_bf16 v[60:63], v[188:191], v[180:183], v[60:63]
    buffer_load_dwordx4 v[160:163], v15, s[36:39], s63 offen offset:2048 sc1
    v_mfma_f32_16x16x32_bf16 v[64:67], v[192:195], v[180:183], v[64:67]
    buffer_load_dwordx4 v[164:167], v15, s[36:39], s63 offen offset:3072 sc1
    v_mfma_f32_16x16x32_bf16 v[68:71], v[196:199], v[180:183], v[68:71]
    buffer_load_dwordx4 v[168:171], v16, s[36:39], s63 offen offset:0 sc1
    s_add_u32 s68, s68, 524288
    s_add_u32 s63, s63, 163840
    v_mfma_f32_16x16x32_bf16 v[72:75], v[200:203], v[180:183], v[72:75]
    v_mfma_f32_16x16x32_bf16 v[76:79], v[204:207], v[180:183], v[76:79]
    v_mfma_f32_16x16x32_bf16 v[80:83], v[188:191], v[184:187], v[80:83]
    v_mfma_f32_16x16x32_bf16 v[84:87], v[192:195], v[184:187], v[84:87]
    v_mfma_f32_16x16x32_bf16 v[88:91], v[196:199], v[184:187], v[88:91]
    v_mfma_f32_16x16x32_bf16 v[92:95], v[200:203], v[184:187], v[92:95]
    v_mfma_f32_16x16x32_bf16 v[96:99], v[204:207], v[184:187], v[96:99]
    s_waitcnt vmcnt(21)
    v_mfma_f32_16x16x32_bf16 v[20:23], v[116:119], v[100:103], v[20:23]
    buffer_load_dwordx4 v[172:175], v11, s[32:35], s68 offen sc1
    v_mfma_f32_16x16x32_bf16 v[24:27], v[120:123], v[100:103], v[24:27]
    buffer_load_dwordx4 v[176:179], v12, s[32:35], s68 offen sc1
    v_mfma_f32_16x16x32_bf16 v[28:31], v[124:127], v[100:103], v[28:31]
    buffer_load_dwordx4 v[180:183], v13, s[32:35], s68 offen sc1
    v_mfma_f32_16x16x32_bf16 v[32:35], v[128:131], v[100:103], v[32:35]
    buffer_load_dwordx4 v[184:187], v14, s[32:35], s68 offen sc1
    v_mfma_f32_16x16x32_bf16 v[36:39], v[132:135], v[100:103], v[36:39]
    buffer_load_dwordx4 v[188:191], v15, s[36:39], s63 offen offset:0 sc1
    v_mfma_f32_16x16x32_bf16 v[40:43], v[116:119], v[104:107], v[40:43]
    buffer_load_dwordx4 v[192:195], v15, s[36:39], s63 offen offset:1024 sc1
    v_mfma_f32_16x16x32_bf16 v[44:47], v[120:123], v[104:107], v[44:47]
    buffer_load_dwordx4 v[196:199], v15, s[36:39], s63 offen offset:2048 sc1
    v_mfma_f32_16x16x32_bf16 v[48:51], v[124:127], v[104:107], v[48:51]
    buffer_load_dwordx4 v[200:203], v15, s[36:39], s63 offen offset:3072 sc1
    v_mfma_f32_16x16x32_bf16 v[52:55], v[128:131], v[104:107], v[52:55]
    buffer_load_dwordx4 v[204:207], v16, s[36:39], s63 offen offset:0 sc1
    s_add_u32 s68, s68, 524288
    s_add_u32 s63, s63, 163840
    v_mfma_f32_16x16x32_bf16 v[56:59], v[132:135], v[104:107], v[56:59]
    v_mfma_f32_16x16x32_bf16 v[60:63], v[116:119], v[108:111], v[60:63]
    v_mfma_f32_16x16x32_bf16 v[64:67], v[120:123], v[108:111], v[64:67]
    v_mfma_f32_16x16x32_bf16 v[68:71], v[124:127], v[108:111], v[68:71]
    v_mfma_f32_16x16x32_bf16 v[72:75], v[128:131], v[108:111], v[72:75]
    v_mfma_f32_16x16x32_bf16 v[76:79], v[132:135], v[108:111], v[76:79]
    v_mfma_f32_16x16x32_bf16 v[80:83], v[116:119], v[112:115], v[80:83]
    v_mfma_f32_16x16x32_bf16 v[84:87], v[120:123], v[112:115], v[84:87]
    v_mfma_f32_16x16x32_bf16 v[88:91], v[124:127], v[112:115], v[88:91]
    v_mfma_f32_16x16x32_bf16 v[92:95], v[128:131], v[112:115], v[92:95]
    v_mfma_f32_16x16x32_bf16 v[96:99], v[132:135], v[112:115], v[96:99]
    s_waitcnt vmcnt(9)
    v_mfma_f32_16x16x32_bf16 v[20:23], v[152:155], v[136:139], v[20:23]
    buffer_load_dwordx4 v[100:103], v11, s[32:35], s68 offen sc1
    v_mfma_f32_16x16x32_bf16 v[24:27], v[156:159], v[136:139], v[24:27]
    buffer_load_dwordx4 v[104:107], v12, s[32:35], s68 offen sc1
    v_mfma_f32_16x16x32_bf16 v[28:31], v[160:163], v[136:139], v[28:31]
    buffer_load_dwordx4 v[108:111], v13, s[32:35], s68 offen sc1
    v_mfma_f32_16x16x32_bf16 v[32:35], v[164:167], v[136:139], v[32:35]
    buffer_load_dwordx4 v[112:115], v14, s[32:35], s68 offen sc1
    s_barrier
    v_mfma_f32_16x16x32_bf16 v[36:39], v[168:171], v[136:139], v[36:39]
    s_and_b32 s58, s74, 7
    s_lshl_b32 s58, s58, 2
    s_add_u32 s58, s58, s45
    s_lshl_b32 s66, s58, 10
    s_add_u32 s66, s66, 2621440
    s_mul_i32 s67, s58, 81920
    s_add_u32 s67, s67, 14942208
    s_add_u32 s74, s74, 1
    s_lshl_b32 s58, s45, 11
    s_add_u32 m0, s58, 141056
    s_lshl_b32 s59, s45, 10
    buffer_load_dwordx4 v8, s[24:27], s66 offen sc1 lds
    v_mfma_f32_16x16x32_bf16 v[40:43], v[152:155], v[140:143], v[40:43]
    buffer_load_dwordx4 v[116:119], v15, s[36:39], s63 offen offset:0 sc1
    v_mfma_f32_16x16x32_bf16 v[44:47], v[156:159], v[140:143], v[44:47]
    s_add_u32 m0, s58, 141568
    s_mul_i32 s58, s45, 2624
    buffer_load_dwordx4 v8, s[24:27], s66 offen offset:512 sc1 lds
    v_mfma_f32_16x16x32_bf16 v[48:51], v[160:163], v[140:143], v[48:51]
    buffer_load_dwordx4 v[120:123], v15, s[36:39], s63 offen offset:1024 sc1
    v_mfma_f32_16x16x32_bf16 v[52:55], v[164:167], v[140:143], v[52:55]
    s_add_u32 m0, s59, 149248
    s_nop 0
    buffer_load_dwordx4 v9, s[24:27], s66 offen sc1 lds
    v_mfma_f32_16x16x32_bf16 v[56:59], v[168:171], v[140:143], v[56:59]
    buffer_load_dwordx4 v[124:127], v15, s[36:39], s63 offen offset:2048 sc1
    v_mfma_f32_16x16x32_bf16 v[60:63], v[152:155], v[144:147], v[60:63]
    s_mov_b32 exec_hi, 0xff
    s_add_u32 m0, s58, 153344
    s_add_u32 s59, s67, 0
    buffer_load_dwordx4 v10, s[24:27], s59 offen sc1 lds
    s_add_u32 m0, s58, 154000
    s_add_u32 s59, s67, 20480
    buffer_load_dwordx4 v10, s[24:27], s59 offen sc1 lds
    s_add_u32 m0, s58, 154656
    s_add_u32 s59, s67, 40960
    buffer_load_dwordx4 v10, s[24:27], s59 offen sc1 lds
    s_add_u32 m0, s58, 155312
    s_add_u32 s59, s67, 61440
    buffer_load_dwordx4 v10, s[24:27], s59 offen sc1 lds
    s_mov_b32 exec_hi, -1
    v_mfma_f32_16x16x32_bf16 v[64:67], v[156:159], v[144:147], v[64:67]
    buffer_load_dwordx4 v[128:131], v15, s[36:39], s63 offen offset:3072 sc1
    v_mfma_f32_16x16x32_bf16 v[68:71], v[160:163], v[144:147], v[68:71]
    s_add_u32 m0, s64, 20480
    s_nop 0
    buffer_load_dwordx4 v15, s[24:27], s62 offen offset:0 sc1 lds
    v_mfma_f32_16x16x32_bf16 v[72:75], v[164:167], v[144:147], v[72:75]
    buffer_load_dwordx4 v[132:135], v16, s[36:39], s63 offen offset:0 sc1
    s_add_u32 s68, s68, 524288
    s_add_u32 s63, s63, 163840
    v_mfma_f32_16x16x32_bf16 v[76:79], v[168:171], v[144:147], v[76:79]
    buffer_load_dwordx4 v15, s[24:27], s62 offen offset:1024 sc1 lds
    v_mfma_f32_16x16x32_bf16 v[80:83], v[152:155], v[148:151], v[80:83]
    buffer_load_dwordx4 v15, s[24:27], s62 offen offset:2048 sc1 lds
    v_mfma_f32_16x16x32_bf16 v[84:87], v[156:159], v[148:151], v[84:87]
    buffer_load_dwordx4 v15, s[24:27], s62 offen offset:3072 sc1 lds
    v_mfma_f32_16x16x32_bf16 v[88:91], v[160:163], v[148:151], v[88:91]
    s_add_u32 m0, s64, 24576
    s_nop 0
    buffer_load_dwordx4 v16, s[24:27], s62 offen offset:0 sc1 lds
    s_add_u32 s62, s62, 163840
    v_mfma_f32_16x16x32_bf16 v[92:95], v[164:167], v[148:151], v[92:95]
    v_mfma_f32_16x16x32_bf16 v[96:99], v[168:171], v[148:151], v[96:99]
    s_waitcnt vmcnt(21)
    v_mfma_f32_16x16x32_bf16 v[20:23], v[188:191], v[172:175], v[20:23]
    buffer_load_dwordx4 v[136:139], v11, s[32:35], s68 offen sc1
    v_mfma_f32_16x16x32_bf16 v[24:27], v[192:195], v[172:175], v[24:27]
    buffer_load_dwordx4 v[140:143], v12, s[32:35], s68 offen sc1
    v_mfma_f32_16x16x32_bf16 v[28:31], v[196:199], v[172:175], v[28:31]
    buffer_load_dwordx4 v[144:147], v13, s[32:35], s68 offen sc1
    v_mfma_f32_16x16x32_bf16 v[32:35], v[200:203], v[172:175], v[32:35]
    buffer_load_dwordx4 v[148:151], v14, s[32:35], s68 offen sc1
    v_mfma_f32_16x16x32_bf16 v[36:39], v[204:207], v[172:175], v[36:39]
    buffer_load_dwordx4 v[152:155], v15, s[36:39], s63 offen offset:0 sc1
    v_mfma_f32_16x16x32_bf16 v[40:43], v[188:191], v[176:179], v[40:43]
    buffer_load_dwordx4 v[156:159], v15, s[36:39], s63 offen offset:1024 sc1
    v_mfma_f32_16x16x32_bf16 v[44:47], v[192:195], v[176:179], v[44:47]
    buffer_load_dwordx4 v[160:163], v15, s[36:39], s63 offen offset:2048 sc1
    v_mfma_f32_16x16x32_bf16 v[48:51], v[196:199], v[176:179], v[48:51]
    buffer_load_dwordx4 v[164:167], v15, s[36:39], s63 offen offset:3072 sc1
    v_mfma_f32_16x16x32_bf16 v[52:55], v[200:203], v[176:179], v[52:55]
    buffer_load_dwordx4 v[168:171], v16, s[36:39], s63 offen offset:0 sc1
    s_add_u32 s68, s68, 524288
    s_add_u32 s63, s63, 163840
    v_mfma_f32_16x16x32_bf16 v[56:59], v[204:207], v[176:179], v[56:59]
    v_mfma_f32_16x16x32_bf16 v[60:63], v[188:191], v[180:183], v[60:63]
    v_mfma_f32_16x16x32_bf16 v[64:67], v[192:195], v[180:183], v[64:67]
    v_mfma_f32_16x16x32_bf16 v[68:71], v[196:199], v[180:183], v[68:71]
    v_mfma_f32_16x16x32_bf16 v[72:75], v[200:203], v[180:183], v[72:75]
    v_mfma_f32_16x16x32_bf16 v[76:79], v[204:207], v[180:183], v[76:79]
    v_mfma_f32_16x16x32_bf16 v[80:83], v[188:191], v[184:187], v[80:83]
    v_mfma_f32_16x16x32_bf16 v[84:87], v[192:195], v[184:187], v[84:87]
    v_mfma_f32_16x16x32_bf16 v[88:91], v[196:199], v[184:187], v[88:91]
    v_mfma_f32_16x16x32_bf16 v[92:95], v[200:203], v[184:187], v[92:95]
    v_mfma_f32_16x16x32_bf16 v[96:99], v[204:207], v[184:187], v[96:99]
    s_waitcnt vmcnt(13)
    v_mfma_f32_16x16x32_bf16 v[20:23], v[116:119], v[100:103], v[20:23]
    buffer_load_dwordx4 v[172:175], v11, s[32:35], s68 offen sc1
    v_mfma_f32_16x16x32_bf16 v[24:27], v[120:123], v[100:103], v[24:27]
    buffer_load_dwordx4 v[176:179], v12, s[32:35], s68 offen sc1
    v_mfma_f32_16x16x32_bf16 v[28:31], v[124:127], v[100:103], v[28:31]
    buffer_load_dwordx4 v[180:183], v13, s[32:35], s68 offen sc1
    v_mfma_f32_16x16x32_bf16 v[32:35], v[128:131], v[100:103], v[32:35]
    buffer_load_dwordx4 v[184:187], v14, s[32:35], s68 offen sc1
    v_mfma_f32_16x16x32_bf16 v[36:39], v[132:135], v[100:103], v[36:39]
    buffer_load_dwordx4 v[188:191], v15, s[36:39], s63 offen offset:0 sc1
    v_mfma_f32_16x16x32_bf16 v[40:43], v[116:119], v[104:107], v[40:43]
    buffer_load_dwordx4 v[192:195], v15, s[36:39], s63 offen offset:1024 sc1
    v_mfma_f32_16x16x32_bf16 v[44:47], v[120:123], v[104:107], v[44:47]
    buffer_load_dwordx4 v[196:199], v15, s[36:39], s63 offen offset:2048 sc1
    v_mfma_f32_16x16x32_bf16 v[48:51], v[124:127], v[104:107], v[48:51]
    buffer_load_dwordx4 v[200:203], v15, s[36:39], s63 offen offset:3072 sc1
    v_mfma_f32_16x16x32_bf16 v[52:55], v[128:131], v[104:107], v[52:55]
    buffer_load_dwordx4 v[204:207], v16, s[36:39], s63 offen offset:0 sc1
    s_add_u32 s68, s68, 524288
    s_add_u32 s63, s63, 163840
    v_mfma_f32_16x16x32_bf16 v[56:59], v[132:135], v[104:107], v[56:59]
    v_mfma_f32_16x16x32_bf16 v[60:63], v[116:119], v[108:111], v[60:63]
    v_mfma_f32_16x16x32_bf16 v[64:67], v[120:123], v[108:111], v[64:67]
    v_mfma_f32_16x16x32_bf16 v[68:71], v[124:127], v[108:111], v[68:71]
    s_barrier
    v_mfma_f32_16x16x32_bf16 v[72:75], v[128:131], v[108:111], v[72:75]
    s_and_b32 s58, s74, 7
    s_lshl_b32 s58, s58, 2
    s_add_u32 s58, s58, s45
    s_lshl_b32 s66, s58, 10
    s_add_u32 s66, s66, 2621440
    s_mul_i32 s67, s58, 81920
    s_add_u32 s67, s67, 14942208
    s_add_u32 s74, s74, 1
    s_lshl_b32 s58, s45, 11
    s_add_u32 m0, s58, 95488
    s_lshl_b32 s59, s45, 10
    buffer_load_dwordx4 v8, s[24:27], s66 offen sc1 lds
    v_mfma_f32_16x16x32_bf16 v[76:79], v[132:135], v[108:111], v[76:79]
    s_add_u32 m0, s58, 96000
    s_mul_i32 s58, s45, 2624
    buffer_load_dwordx4 v8, s[24:27], s66 offen offset:512 sc1 lds
    v_mfma_f32_16x16x32_bf16 v[80:83], v[116:119], v[112:115], v[80:83]
    s_add_u32 m0, s59, 103680
    s_nop 0
    buffer_load_dwordx4 v9, s[24:27], s66 offen sc1 lds
    v_mfma_f32_16x16x32_bf16 v[84:87], v[120:123], v[112:115], v[84:87]
    s_mov_b32 exec_hi, 0xff
    s_add_u32 m0, s58, 107776
    s_add_u32 s59, s67, 0
    buffer_load_dwordx4 v10, s[24:27], s59 offen sc1 lds
    s_add_u32 m0, s58, 108432
    s_add_u32 s59, s67, 20480
    buffer_load_dwordx4 v10, s[24:27], s59 offen sc1 lds
    s_add_u32 m0, s58, 109088
    s_add_u32 s59, s67, 40960
    buffer_load_dwordx4 v10, s[24:27], s59 offen sc1 lds
    s_add_u32 m0, s58, 109744
    s_add_u32 s59, s67, 61440
    buffer_load_dwordx4 v10, s[24:27], s59 offen sc1 lds
    s_mov_b32 exec_hi, -1
    v_mfma_f32_16x16x32_bf16 v[88:91], v[124:127], v[112:115], v[88:91]
    s_mov_b32 s28, s4
    s_mov_b32 s29, s5
    s_mov_b32 s30, 2621440
    s_mov_b32 s31, 0x00020000
    s_mov_b32 s88, s18
    s_mov_b32 s89, s19
    s_mov_b32 s90, 1280
    s_mov_b32 s91, 0x00020000
    s_mov_b32 s40, s20
    s_mov_b32 s41, s21
    s_mov_b32 s42, 2621440
    s_mov_b32 s43, 0x00020000
    s_mov_b32 s57, 21137408
    buffer_load_dword v208, v250, s[24:27], s57 offen sc1
    v_mfma_f32_16x16x32_bf16 v[92:95], v[128:131], v[112:115], v[92:95]
    buffer_load_dwordx4 v[220:223], v17, s[28:31], 0 offen
    v_mfma_f32_16x16x32_bf16 v[96:99], v[132:135], v[112:115], v[96:99]
    buffer_load_dwordx4 v[224:227], v17, s[28:31], 0 offen offset:64
    s_waitcnt vmcnt(19)
    v_mfma_f32_16x16x32_bf16 v[20:23], v[152:155], v[136:139], v[20:23]
    buffer_load_dwordx2 v[228:229], v18, s[28:31], 0 offen offset:128
    v_mfma_f32_16x16x32_bf16 v[24:27], v[156:159], v[136:139], v[24:27]
    buffer_load_dwordx4 v[100:103], v11, s[32:35], s68 offen sc1
    v_mfma_f32_16x16x32_bf16 v[28:31], v[160:163], v[136:139], v[28:31]
    buffer_load_dwordx4 v[230:233], v2, s[88:91], 0 offen
    v_mfma_f32_16x16x32_bf16 v[32:35], v[164:167], v[136:139], v[32:35]
    buffer_load_dwordx4 v[104:107], v12, s[32:35], s68 offen sc1
    v_mfma_f32_16x16x32_bf16 v[36:39], v[168:171], v[136:139], v[36:39]
    buffer_load_dwordx4 v[234:237], v2, s[88:91], 0 offen offset:64
    v_mfma_f32_16x16x32_bf16 v[40:43], v[152:155], v[140:143], v[40:43]
    buffer_load_dwordx4 v[108:111], v13, s[32:35], s68 offen sc1
    v_mfma_f32_16x16x32_bf16 v[44:47], v[156:159], v[140:143], v[44:47]
    buffer_load_dwordx2 v[238:239], v3, s[88:91], 0 offen offset:128
    v_mfma_f32_16x16x32_bf16 v[48:51], v[160:163], v[140:143], v[48:51]
    buffer_load_dwordx4 v[112:115], v14, s[32:35], s68 offen sc1
    v_mfma_f32_16x16x32_bf16 v[52:55], v[164:167], v[140:143], v[52:55]
    buffer_load_dwordx4 v[116:119], v15, s[36:39], s63 offen offset:0 sc1
    v_mfma_f32_16x16x32_bf16 v[56:59], v[168:171], v[140:143], v[56:59]
    buffer_load_dwordx4 v[120:123], v15, s[36:39], s63 offen offset:1024 sc1
    v_mfma_f32_16x16x32_bf16 v[60:63], v[152:155], v[144:147], v[60:63]
    buffer_load_dwordx4 v[124:127], v15, s[36:39], s63 offen offset:2048 sc1
    v_mfma_f32_16x16x32_bf16 v[64:67], v[156:159], v[144:147], v[64:67]
    buffer_load_dwordx4 v[128:131], v15, s[36:39], s63 offen offset:3072 sc1
    v_mfma_f32_16x16x32_bf16 v[68:71], v[160:163], v[144:147], v[68:71]
    buffer_load_dwordx4 v[132:135], v16, s[36:39], s63 offen offset:0 sc1
    s_add_u32 s68, s68, 524288
    s_add_u32 s63, s63, 163840
    v_mfma_f32_16x16x32_bf16 v[72:75], v[164:167], v[144:147], v[72:75]
    v_mfma_f32_16x16x32_bf16 v[76:79], v[168:171], v[144:147], v[76:79]
    v_mfma_f32_16x16x32_bf16 v[80:83], v[152:155], v[148:151], v[80:83]
    v_mfma_f32_16x16x32_bf16 v[84:87], v[156:159], v[148:151], v[84:87]
    v_mfma_f32_16x16x32_bf16 v[88:91], v[160:163], v[148:151], v[88:91]
    v_mfma_f32_16x16x32_bf16 v[92:95], v[164:167], v[148:151], v[92:95]
    v_mfma_f32_16x16x32_bf16 v[96:99], v[168:171], v[148:151], v[96:99]
    s_waitcnt vmcnt(23)
    v_mfma_f32_16x16x32_bf16 v[20:23], v[188:191], v[172:175], v[20:23]
    buffer_load_dwordx4 v[136:139], v11, s[32:35], s68 offen sc1
    v_mfma_f32_16x16x32_bf16 v[24:27], v[192:195], v[172:175], v[24:27]
    buffer_load_dwordx4 v[140:143], v12, s[32:35], s68 offen sc1
    v_mfma_f32_16x16x32_bf16 v[28:31], v[196:199], v[172:175], v[28:31]
    buffer_load_dwordx4 v[144:147], v13, s[32:35], s68 offen sc1
    v_mfma_f32_16x16x32_bf16 v[32:35], v[200:203], v[172:175], v[32:35]
    buffer_load_dwordx4 v[148:151], v14, s[32:35], s68 offen sc1
    v_mfma_f32_16x16x32_bf16 v[36:39], v[204:207], v[172:175], v[36:39]
    buffer_load_dwordx4 v[152:155], v15, s[36:39], s63 offen offset:0 sc1
    v_mfma_f32_16x16x32_bf16 v[40:43], v[188:191], v[176:179], v[40:43]
    buffer_load_dwordx4 v[156:159], v15, s[36:39], s63 offen offset:1024 sc1
    v_mfma_f32_16x16x32_bf16 v[44:47], v[192:195], v[176:179], v[44:47]
    buffer_load_dwordx4 v[160:163], v15, s[36:39], s63 offen offset:2048 sc1
    v_mfma_f32_16x16x32_bf16 v[48:51], v[196:199], v[176:179], v[48:51]
    buffer_load_dwordx4 v[164:167], v15, s[36:39], s63 offen offset:3072 sc1
    v_mfma_f32_16x16x32_bf16 v[52:55], v[200:203], v[176:179], v[52:55]
    buffer_load_dwordx4 v[168:171], v16, s[36:39], s63 offen offset:0 sc1
    s_add_u32 s68, s68, 524288
    s_add_u32 s63, s63, 163840
    v_mfma_f32_16x16x32_bf16 v[56:59], v[204:207], v[176:179], v[56:59]
    v_mfma_f32_16x16x32_bf16 v[60:63], v[188:191], v[180:183], v[60:63]
    v_mfma_f32_16x16x32_bf16 v[64:67], v[192:195], v[180:183], v[64:67]
    v_mfma_f32_16x16x32_bf16 v[68:71], v[196:199], v[180:183], v[68:71]
    v_mfma_f32_16x16x32_bf16 v[72:75], v[200:203], v[180:183], v[72:75]
    v_mfma_f32_16x16x32_bf16 v[76:79], v[204:207], v[180:183], v[76:79]
    v_mfma_f32_16x16x32_bf16 v[80:83], v[188:191], v[184:187], v[80:83]
    v_mfma_f32_16x16x32_bf16 v[84:87], v[192:195], v[184:187], v[84:87]
    v_mfma_f32_16x16x32_bf16 v[88:91], v[196:199], v[184:187], v[88:91]
    v_mfma_f32_16x16x32_bf16 v[92:95], v[200:203], v[184:187], v[92:95]
    v_mfma_f32_16x16x32_bf16 v[96:99], v[204:207], v[184:187], v[96:99]
    s_waitcnt vmcnt(9)
    v_mfma_f32_16x16x32_bf16 v[20:23], v[116:119], v[100:103], v[20:23]
    v_mfma_f32_16x16x32_bf16 v[24:27], v[120:123], v[100:103], v[24:27]
    s_barrier
    v_mfma_f32_16x16x32_bf16 v[28:31], v[124:127], v[100:103], v[28:31]
    s_add_u32 m0, s64, 40960
    s_nop 0
    buffer_load_dwordx4 v15, s[24:27], s62 offen offset:0 sc1 lds
    v_mfma_f32_16x16x32_bf16 v[32:35], v[128:131], v[100:103], v[32:35]
    buffer_load_dwordx4 v15, s[24:27], s62 offen offset:1024 sc1 lds
    v_mfma_f32_16x16x32_bf16 v[36:39], v[132:135], v[100:103], v[36:39]
    buffer_load_dwordx4 v15, s[24:27], s62 offen offset:2048 sc1 lds
    v_mfma_f32_16x16x32_bf16 v[40:43], v[116:119], v[104:107], v[40:43]
    buffer_load_dwordx4 v15, s[24:27], s62 offen offset:3072 sc1 lds
    v_mfma_f32_16x16x32_bf16 v[44:47], v[120:123], v[104:107], v[44:47]
    s_add_u32 m0, s64, 45056
    s_nop 0
    buffer_load_dwordx4 v16, s[24:27], s62 offen offset:0 sc1 lds
    s_add_u32 s62, s62, 163840
    v_mfma_f32_16x16x32_bf16 v[48:51], v[124:127], v[104:107], v[48:51]
    s_add_u32 m0, s64, 61440
    s_nop 0
    buffer_load_dwordx4 v15, s[24:27], s62 offen offset:0 sc1 lds
    v_mfma_f32_16x16x32_bf16 v[52:55], v[128:131], v[104:107], v[52:55]
    buffer_load_dwordx4 v15, s[24:27], s62 offen offset:1024 sc1 lds
    v_mfma_f32_16x16x32_bf16 v[56:59], v[132:135], v[104:107], v[56:59]
    buffer_load_dwordx4 v15, s[24:27], s62 offen offset:2048 sc1 lds
    v_mfma_f32_16x16x32_bf16 v[60:63], v[116:119], v[108:111], v[60:63]
    buffer_load_dwordx4 v15, s[24:27], s62 offen offset:3072 sc1 lds
    v_mfma_f32_16x16x32_bf16 v[64:67], v[120:123], v[108:111], v[64:67]
    s_add_u32 m0, s64, 65536
    s_nop 0
    buffer_load_dwordx4 v16, s[24:27], s62 offen offset:0 sc1 lds
    s_add_u32 s62, s62, 163840
    v_mfma_f32_16x16x32_bf16 v[68:71], v[124:127], v[108:111], v[68:71]
    v_mfma_f32_16x16x32_bf16 v[72:75], v[128:131], v[108:111], v[72:75]
    v_mfma_f32_16x16x32_bf16 v[76:79], v[132:135], v[108:111], v[76:79]
    v_mfma_f32_16x16x32_bf16 v[80:83], v[116:119], v[112:115], v[80:83]
    v_mfma_f32_16x16x32_bf16 v[84:87], v[120:123], v[112:115], v[84:87]
    v_mfma_f32_16x16x32_bf16 v[88:91], v[124:127], v[112:115], v[88:91]
    v_mfma_f32_16x16x32_bf16 v[92:95], v[128:131], v[112:115], v[92:95]
    v_mfma_f32_16x16x32_bf16 v[96:99], v[132:135], v[112:115], v[96:99]
    s_waitcnt vmcnt(10)
    s_cmp_lt_u32 s45, 2
    s_cbranch_scc0 L_m13
    v_mfma_f32_16x16x32_bf16 v[20:23], v[152:155], v[136:139], v[20:23]
    s_add_u32 m0, s64, 81920
    s_nop 0
    buffer_load_dwordx4 v15, s[24:27], s62 offen offset:0 sc1 lds
    v_mfma_f32_16x16x32_bf16 v[24:27], v[156:159], v[136:139], v[24:27]
    buffer_load_dwordx4 v15, s[24:27], s62 offen offset:1024 sc1 lds
    v_mfma_f32_16x16x32_bf16 v[28:31], v[160:163], v[136:139], v[28:31]
    buffer_load_dwordx4 v15, s[24:27], s62 offen offset:2048 sc1 lds
    v_mfma_f32_16x16x32_bf16 v[32:35], v[164:167], v[136:139], v[32:35]
    buffer_load_dwordx4 v15, s[24:27], s62 offen offset:3072 sc1 lds
    v_mfma_f32_16x16x32_bf16 v[36:39], v[168:171], v[136:139], v[36:39]
    s_add_u32 m0, s64, 86016
    s_nop 0
    buffer_load_dwordx4 v16, s[24:27], s62 offen offset:0 sc1 lds
    s_add_u32 s62, s62, 163840
    v_mfma_f32_16x16x32_bf16 v[40:43], v[152:155], v[140:143], v[40:43]
    v_mfma_f32_16x16x32_bf16 v[44:47], v[156:159], v[140:143], v[44:47]
    v_mfma_f32_16x16x32_bf16 v[48:51], v[160:163], v[140:143], v[48:51]
    v_mfma_f32_16x16x32_bf16 v[52:55], v[164:167], v[140:143], v[52:55]
    v_mfma_f32_16x16x32_bf16 v[56:59], v[168:171], v[140:143], v[56:59]
    v_mfma_f32_16x16x32_bf16 v[60:63], v[152:155], v[144:147], v[60:63]
    v_mfma_f32_16x16x32_bf16 v[64:67], v[156:159], v[144:147], v[64:67]
    v_mfma_f32_16x16x32_bf16 v[68:71], v[160:163], v[144:147], v[68:71]
    v_mfma_f32_16x16x32_bf16 v[72:75], v[164:167], v[144:147], v[72:75]
    v_mfma_f32_16x16x32_bf16 v[76:79], v[168:171], v[144:147], v[76:79]
    v_mfma_f32_16x16x32_bf16 v[80:83], v[152:155], v[148:151], v[80:83]
    v_mfma_f32_16x16x32_bf16 v[84:87], v[156:159], v[148:151], v[84:87]
    v_mfma_f32_16x16x32_bf16 v[88:91], v[160:163], v[148:151], v[88:91]
    v_mfma_f32_16x16x32_bf16 v[92:95], v[164:167], v[148:151], v[92:95]
    v_mfma_f32_16x16x32_bf16 v[96:99], v[168:171], v[148:151], v[96:99]
L_m13:
    s_cmp_ge_u32 s45, 2
    s_cbranch_scc0 L_wl
    buffer_load_dwordx4 v[180:183], v15, s[24:27], s62 offen offset:0 sc1
    buffer_load_dwordx4 v[184:187], v15, s[24:27], s62 offen offset:1024 sc1
    buffer_load_dwordx4 v[188:191], v15, s[24:27], s62 offen offset:2048 sc1
    buffer_load_dwordx4 v[192:195], v15, s[24:27], s62 offen offset:3072 sc1
    buffer_load_dwordx4 v[196:199], v16, s[24:27], s62 offen offset:0 sc1
L_wl:
    s_waitcnt lgkmcnt(10)
    ds_read_b128 v[100:103], v19 offset:10240
    ds_read_b128 v[104:107], v19 offset:11264
    ds_read_b128 v[108:111], v19 offset:12288
    ds_read_b128 v[112:115], v19 offset:13312
    ds_read_b128 v[116:119], v19 offset:14336
    s_waitcnt lgkmcnt(10)
    ds_read_b128 v[120:123], v19 offset:15360
    ds_read_b128 v[124:127], v19 offset:16384
    ds_read_b128 v[128:131], v19 offset:17408
    ds_read_b128 v[132:135], v19 offset:18432
    ds_read_b128 v[136:139], v19 offset:19456
    s_waitcnt lgkmcnt(10)
    ds_read_b128 v[140:143], v19 offset:20480
    ds_read_b128 v[144:147], v19 offset:21504
    ds_read_b128 v[148:151], v19 offset:22528
    ds_read_b128 v[152:155], v19 offset:23552
    ds_read_b128 v[156:159], v19 offset:24576
    s_waitcnt lgkmcnt(10)
    ds_read_b128 v[160:163], v19 offset:25600
    ds_read_b128 v[164:167], v19 offset:26624
    ds_read_b128 v[168:171], v19 offset:27648
    ds_read_b128 v[172:175], v19 offset:28672
    ds_read_b128 v[176:179], v19 offset:29696
    v_cmp_ne_u32 vcc, s55, v208
    s_nop 3
    s_cbranch_vccz L_wm_done
    s_mov_b32 s58, 21137408
    s_mov_b32 s69, 131072
    s_branch L_wm_ld
L_wm:
    s_sleep 1
L_wm_ld:
    buffer_load_dword v5, v250, s[24:27], s58 offen sc1
    s_sub_u32 s69, s69, 1
    s_waitcnt vmcnt(0)
    v_mov_b32 v6, v5
    v_cmp_ne_u32 vcc, s55, v5
    v_cmp_ne_u32 s[60:61], s55, v6
    s_cmp_eq_u32 s69, 0
    s_cbranch_scc1 L_wm_done
    s_or_b64 vcc, vcc, s[60:61]
    s_cbranch_scc1 L_wm
L_wm_done:
    v_bfe_u32 v4, v1, 1, 4
    v_mul_u32_u24 v4, 5, v4
    v_and_b32 v5, 1, v1
    s_cmp_eq_u32 s45, 2
    s_cselect_b32 s59, 8, 98304
    s_cselect_b32 s60, 4, 12
    s_cmp_eq_u32 s45, 3
    s_cselect_b32 s58, 0, s45
    v_add_u32 v4, s58, v4
    v_lshlrev_b32 v4, 15, v4
    v_mad_u32_u24 v2, v5, s59, v4
    s_lshl_b32 s58, s48, 3
    s_add_u32 s58, s58, s49
    s_lshl_b32 s58, s58, 7
    s_add_u32 s58, s58, s60
    s_add_u32 s66, s58, 12320768
    s_mov_b32 s69, 131072
    s_waitcnt lgkmcnt(0)
    s_barrier
    s_add_u32 s58, s64, 122880
    v_add_u32 v4, s58, v19
    ds_write_b128 v4, v[40:43] offset:0
    ds_write_b128 v4, v[44:47] offset:1024
    ds_write_b128 v4, v[48:51] offset:2048
    ds_write_b128 v4, v[52:55] offset:3072
    ds_write_b128 v4, v[56:59] offset:4096
    s_add_u32 s58, s64, 143360
    v_add_u32 v4, s58, v19
    ds_write_b128 v4, v[60:63] offset:0
    ds_write_b128 v4, v[64:67] offset:1024
    ds_write_b128 v4, v[68:71] offset:2048
    ds_write_b128 v4, v[72:75] offset:3072
    ds_write_b128 v4, v[76:79] offset:4096
    s_barrier
    s_waitcnt vmcnt(0) lgkmcnt(0)
    s_add_u32 s58, s64, 102400
    v_add_u32 v4, s58, v19
    ds_write_b128 v4, v[80:83] offset:0
    ds_write_b128 v4, v[84:87] offset:1024
    ds_write_b128 v4, v[88:91] offset:2048
    ds_write_b128 v4, v[92:95] offset:3072
    ds_write_b128 v4, v[96:99] offset:4096
    s_cmp_ge_u32 s45, 2
    s_cbranch_scc0 L_wp
    s_add_u32 s58, s64, 81920
    v_add_u32 v4, s58, v19
    ds_write_b128 v4, v[180:183] offset:0
    ds_write_b128 v4, v[184:187] offset:1024
    ds_write_b128 v4, v[188:191] offset:2048
    ds_write_b128 v4, v[192:195] offset:3072
    ds_write_b128 v4, v[196:199] offset:4096
L_wp:
    s_waitcnt lgkmcnt(0)
    s_barrier
    s_cmp_lg_u32 s2, 0
    s_cbranch_scc1 L_tag_kept
    v_mov_b32 v6, 0
    v_mov_b32 v7, s55
    s_mov_b32 s58, 21170176
    buffer_store_dword v7, v6, s[24:27], s58 offen sc1
L_tag_kept:
    s_xor_b32 s58, s45, 1
    s_mul_i32 s58, s58, 5120
    s_add_u32 s58, s58, 122880
    v_add_u32 v4, s58, v19
    ds_read_b128 v[40:43], v4 offset:0
    ds_read_b128 v[44:47], v4 offset:1024
    ds_read_b128 v[48:51], v4 offset:2048
    ds_read_b128 v[52:55], v4 offset:3072
    ds_read_b128 v[56:59], v4 offset:4096
    s_xor_b32 s58, s45, 2
    s_mul_i32 s58, s58, 5120
    s_add_u32 s58, s58, 143360
    v_add_u32 v4, s58, v19
    ds_read_b128 v[60:63], v4 offset:0
    ds_read_b128 v[64:67], v4 offset:1024
    ds_read_b128 v[68:71], v4 offset:2048
    ds_read_b128 v[72:75], v4 offset:3072
    ds_read_b128 v[76:79], v4 offset:4096
    s_xor_b32 s58, s45, 3
    s_mul_i32 s58, s58, 5120
    s_add_u32 s58, s58, 102400
    v_add_u32 v4, s58, v19
    ds_read_b128 v[80:83], v4 offset:0
    ds_read_b128 v[84:87], v4 offset:1024
    ds_read_b128 v[88:91], v4 offset:2048
    ds_read_b128 v[92:95], v4 offset:3072
    ds_read_b128 v[96:99], v4 offset:4096
    v_lshlrev_b32 v4, 16, v220
    v_and_b32 v5, 0xffff0000, v220
    v_pk_add_f32 v[20:21], v[20:21], v[4:5]
    v_lshlrev_b32 v6, 16, v221
    v_and_b32 v7, 0xffff0000, v221
    v_pk_add_f32 v[22:23], v[22:23], v[6:7]
    v_lshlrev_b32 v4, 16, v222
    v_and_b32 v5, 0xffff0000, v222
    v_pk_add_f32 v[24:25], v[24:25], v[4:5]
    v_lshlrev_b32 v6, 16, v223
    v_and_b32 v7, 0xffff0000, v223
    v_pk_add_f32 v[26:27], v[26:27], v[6:7]
    v_lshlrev_b32 v4, 16, v224
    v_and_b32 v5, 0xffff0000, v224
    v_pk_add_f32 v[28:29], v[28:29], v[4:5]
    v_lshlrev_b32 v6, 16, v225
    v_and_b32 v7, 0xffff0000, v225
    v_pk_add_f32 v[30:31], v[30:31], v[6:7]
    v_lshlrev_b32 v4, 16, v226
    v_and_b32 v5, 0xffff0000, v226
    v_pk_add_f32 v[32:33], v[32:33], v[4:5]
    v_lshlrev_b32 v6, 16, v227
    v_and_b32 v7, 0xffff0000, v227
    v_pk_add_f32 v[34:35], v[34:35], v[6:7]
    v_lshlrev_b32 v4, 16, v228
    v_and_b32 v5, 0xffff0000, v228
    v_pk_add_f32 v[36:37], v[36:37], v[4:5]
    v_lshlrev_b32 v6, 16, v229
    v_and_b32 v7, 0xffff0000, v229
    v_pk_add_f32 v[38:39], v[38:39], v[6:7]
    v_lshlrev_b32 v4, 16, v230
    v_and_b32 v5, 0xffff0000, v230
    v_pk_add_f32 v[20:21], v[20:21], v[4:5]
    v_lshlrev_b32 v6, 16, v231
    v_and_b32 v7, 0xffff0000, v231
    v_pk_add_f32 v[22:23], v[22:23], v[6:7]
    v_lshlrev_b32 v4, 16, v232
    v_and_b32 v5, 0xffff0000, v232
    v_pk_add_f32 v[24:25], v[24:25], v[4:5]
    v_lshlrev_b32 v6, 16, v233
    v_and_b32 v7, 0xffff0000, v233
    v_pk_add_f32 v[26:27], v[26:27], v[6:7]
    v_lshlrev_b32 v4, 16, v234
    v_and_b32 v5, 0xffff0000, v234
    v_pk_add_f32 v[28:29], v[28:29], v[4:5]
    v_lshlrev_b32 v6, 16, v235
    v_and_b32 v7, 0xffff0000, v235
    v_pk_add_f32 v[30:31], v[30:31], v[6:7]
    v_lshlrev_b32 v4, 16, v236
    v_and_b32 v5, 0xffff0000, v236
    v_pk_add_f32 v[32:33], v[32:33], v[4:5]
    v_lshlrev_b32 v6, 16, v237
    v_and_b32 v7, 0xffff0000, v237
    v_pk_add_f32 v[34:35], v[34:35], v[6:7]
    v_lshlrev_b32 v4, 16, v238
    v_and_b32 v5, 0xffff0000, v238
    v_pk_add_f32 v[36:37], v[36:37], v[4:5]
    v_lshlrev_b32 v6, 16, v239
    v_and_b32 v7, 0xffff0000, v239
    v_pk_add_f32 v[38:39], v[38:39], v[6:7]
    s_waitcnt lgkmcnt(10)
    v_pk_add_f32 v[20:21], v[20:21], v[40:41]
    v_pk_add_f32 v[22:23], v[22:23], v[42:43]
    v_pk_add_f32 v[24:25], v[24:25], v[44:45]
    v_pk_add_f32 v[26:27], v[26:27], v[46:47]
    v_pk_add_f32 v[28:29], v[28:29], v[48:49]
    v_pk_add_f32 v[30:31], v[30:31], v[50:51]
    v_pk_add_f32 v[32:33], v[32:33], v[52:53]
    v_pk_add_f32 v[34:35], v[34:35], v[54:55]
    v_pk_add_f32 v[36:37], v[36:37], v[56:57]
    v_pk_add_f32 v[38:39], v[38:39], v[58:59]
    s_waitcnt lgkmcnt(5)
    v_pk_add_f32 v[20:21], v[20:21], v[60:61]
    v_pk_add_f32 v[22:23], v[22:23], v[62:63]
    v_pk_add_f32 v[24:25], v[24:25], v[64:65]
    v_pk_add_f32 v[26:27], v[26:27], v[66:67]
    v_pk_add_f32 v[28:29], v[28:29], v[68:69]
    v_pk_add_f32 v[30:31], v[30:31], v[70:71]
    v_pk_add_f32 v[32:33], v[32:33], v[72:73]
    v_pk_add_f32 v[34:35], v[34:35], v[74:75]
    v_pk_add_f32 v[36:37], v[36:37], v[76:77]
    v_pk_add_f32 v[38:39], v[38:39], v[78:79]
    s_waitcnt lgkmcnt(0)
    v_pk_add_f32 v[20:21], v[20:21], v[80:81]
    v_pk_add_f32 v[22:23], v[22:23], v[82:83]
    v_pk_add_f32 v[24:25], v[24:25], v[84:85]
    v_pk_add_f32 v[26:27], v[26:27], v[86:87]
    v_pk_add_f32 v[28:29], v[28:29], v[88:89]
    v_pk_add_f32 v[30:31], v[30:31], v[90:91]
    v_pk_add_f32 v[32:33], v[32:33], v[92:93]
    v_pk_add_f32 v[34:35], v[34:35], v[94:95]
    v_pk_add_f32 v[36:37], v[36:37], v[96:97]
    v_pk_add_f32 v[38:39], v[38:39], v[98:99]
    v_add_u32 v4, 51200, v19
L_first:
    s_mov_b32 exec_hi, 0
    buffer_load_dword v5, v2, s[24:27], s66 offen sc1
    s_mov_b32 exec_hi, -1
    s_waitcnt lgkmcnt(10)
    ds_read_b128 v[60:63], v19 offset:0
    ds_read_b128 v[64:67], v19 offset:1024
    ds_read_b128 v[68:71], v19 offset:2048
    ds_read_b128 v[72:75], v19 offset:3072
    ds_read_b128 v[76:79], v19 offset:4096
    s_waitcnt lgkmcnt(10)
    ds_read_b128 v[80:83], v19 offset:5120
    ds_read_b128 v[84:87], v19 offset:6144
    ds_read_b128 v[88:91], v19 offset:7168
    ds_read_b128 v[92:95], v19 offset:8192
    ds_read_b128 v[96:99], v19 offset:9216
    s_waitcnt lgkmcnt(10)
    ds_read_b128 v[180:183], v19 offset:30720
    ds_read_b128 v[184:187], v19 offset:31744
    ds_read_b128 v[188:191], v19 offset:32768
    ds_read_b128 v[192:195], v19 offset:33792
    ds_read_b128 v[196:199], v19 offset:34816
    v_mov_b32 v6, 0
    s_mov_b32 exec_hi, 0
    s_branch L_seen
L_poll:
    s_mov_b32 exec_lo, vcc_lo
    buffer_load_dword v5, v2, s[24:27], s66 offen sc1
L_seen:
    s_sub_u32 s69, s69, 1
    s_cmp_lt_i32 s69, 0
    s_waitcnt vmcnt(0) lgkmcnt(0)
    v_cmp_eq_u32 vcc, -1, v5
    s_cbranch_scc1 L_got
    s_nop 2
    s_cbranch_vccnz L_poll
L_got:
    s_mov_b64 exec, -1
    s_mov_b32 s58, 12320768
    buffer_load_dwordx4 v[200:203], v11, s[24:27], s58 offen sc1
    s_mov_b32 s58, 12451840
    buffer_load_dwordx4 v[204:207], v11, s[24:27], s58 offen sc1
    s_mov_b32 s58, 12582912
    buffer_load_dwordx4 v[208:211], v11, s[24:27], s58 offen sc1
    s_mov_b32 s58, 12713984
    buffer_load_dwordx4 v[212:215], v11, s[24:27], s58 offen sc1
    s_mov_b32 s58, 12845056
    buffer_load_dwordx4 v[216:219], v11, s[24:27], s58 offen sc1
    s_mov_b32 s58, 12976128
    buffer_load_dwordx4 v[220:223], v11, s[24:27], s58 offen sc1
    s_waitcnt vmcnt(5)
    v_mfma_f32_16x16x32_bf16 v[40:43], v[60:63], v[200:203], 0
    s_mov_b32 s58, 13107200
    buffer_load_dwordx4 v[224:227], v11, s[24:27], s58 offen sc1
    v_mfma_f32_16x16x32_bf16 v[44:47], v[64:67], v[200:203], 0
    ds_read_b128 v[60:63], v19 offset:35840
    v_mfma_f32_16x16x32_bf16 v[48:51], v[68:71], v[200:203], 0
    ds_read_b128 v[64:67], v19 offset:36864
    v_mfma_f32_16x16x32_bf16 v[52:55], v[72:75], v[200:203], 0
    ds_read_b128 v[68:71], v19 offset:37888
    v_mfma_f32_16x16x32_bf16 v[56:59], v[76:79], v[200:203], 0
    ds_read_b128 v[72:75], v19 offset:38912
    v_max3_u32 v6, v6, v201, v203
    s_waitcnt vmcnt(5)
    v_mfma_f32_16x16x32_bf16 v[40:43], v[80:83], v[204:207], v[40:43]
    s_mov_b32 s58, 13238272
    buffer_load_dwordx4 v[200:203], v11, s[24:27], s58 offen sc1
    v_mfma_f32_16x16x32_bf16 v[44:47], v[84:87], v[204:207], v[44:47]
    ds_read_b128 v[76:79], v19 offset:39936
    v_mfma_f32_16x16x32_bf16 v[48:51], v[88:91], v[204:207], v[48:51]
    ds_read_b128 v[80:83], v19 offset:40960
    v_mfma_f32_16x16x32_bf16 v[52:55], v[92:95], v[204:207], v[52:55]
    ds_read_b128 v[84:87], v19 offset:41984
    v_mfma_f32_16x16x32_bf16 v[56:59], v[96:99], v[204:207], v[56:59]
    ds_read_b128 v[88:91], v19 offset:43008
    v_max3_u32 v6, v6, v205, v207
    s_waitcnt vmcnt(5)
    v_mfma_f32_16x16x32_bf16 v[40:43], v[100:103], v[208:211], v[40:43]
    s_mov_b32 s58, 13369344
    buffer_load_dwordx4 v[204:207], v11, s[24:27], s58 offen sc1
    v_mfma_f32_16x16x32_bf16 v[44:47], v[104:107], v[208:211], v[44:47]
    ds_read_b128 v[92:95], v19 offset:44032
    v_mfma_f32_16x16x32_bf16 v[48:51], v[108:111], v[208:211], v[48:51]
    ds_read_b128 v[96:99], v19 offset:45056
    v_mfma_f32_16x16x32_bf16 v[52:55], v[112:115], v[208:211], v[52:55]
    ds_read_b128 v[100:103], v19 offset:46080
    v_mfma_f32_16x16x32_bf16 v[56:59], v[116:119], v[208:211], v[56:59]
    ds_read_b128 v[104:107], v19 offset:47104
    v_max3_u32 v6, v6, v209, v211
    s_waitcnt vmcnt(5)
    v_mfma_f32_16x16x32_bf16 v[40:43], v[120:123], v[212:215], v[40:43]
    s_mov_b32 s58, 13500416
    buffer_load_dwordx4 v[208:211], v11, s[24:27], s58 offen sc1
    v_mfma_f32_16x16x32_bf16 v[44:47], v[124:127], v[212:215], v[44:47]
    ds_read_b128 v[108:111], v19 offset:48128
    v_mfma_f32_16x16x32_bf16 v[48:51], v[128:131], v[212:215], v[48:51]
    ds_read_b128 v[112:115], v19 offset:49152
    v_mfma_f32_16x16x32_bf16 v[52:55], v[132:135], v[212:215], v[52:55]
    ds_read_b128 v[116:119], v19 offset:50176
    v_mfma_f32_16x16x32_bf16 v[56:59], v[136:139], v[212:215], v[56:59]
    ds_read_b128 v[120:123], v4 offset:0
    v_max3_u32 v6, v6, v213, v215
    s_waitcnt vmcnt(5)
    v_mfma_f32_16x16x32_bf16 v[40:43], v[140:143], v[216:219], v[40:43]
    s_mov_b32 s58, 13631488
    buffer_load_dwordx4 v[212:215], v11, s[24:27], s58 offen sc1
    v_mfma_f32_16x16x32_bf16 v[44:47], v[144:147], v[216:219], v[44:47]
    ds_read_b128 v[124:127], v4 offset:1024
    v_mfma_f32_16x16x32_bf16 v[48:51], v[148:151], v[216:219], v[48:51]
    ds_read_b128 v[128:131], v4 offset:2048
    v_mfma_f32_16x16x32_bf16 v[52:55], v[152:155], v[216:219], v[52:55]
    ds_read_b128 v[132:135], v4 offset:3072
    v_mfma_f32_16x16x32_bf16 v[56:59], v[156:159], v[216:219], v[56:59]
    ds_read_b128 v[136:139], v4 offset:4096
    v_max3_u32 v6, v6, v217, v219
    s_waitcnt vmcnt(5)
    v_mfma_f32_16x16x32_bf16 v[40:43], v[160:163], v[220:223], v[40:43]
    s_mov_b32 s58, 13762560
    buffer_load_dwordx4 v[216:219], v11, s[24:27], s58 offen sc1
    v_mfma_f32_16x16x32_bf16 v[44:47], v[164:167], v[220:223], v[44:47]
    ds_read_b128 v[140:143], v4 offset:5120
    v_mfma_f32_16x16x32_bf16 v[48:51], v[168:171], v[220:223], v[48:51]
    ds_read_b128 v[144:147], v4 offset:6144
    v_mfma_f32_16x16x32_bf16 v[52:55], v[172:175], v[220:223], v[52:55]
    ds_read_b128 v[148:151], v4 offset:7168
    v_mfma_f32_16x16x32_bf16 v[56:59], v[176:179], v[220:223], v[56:59]
    ds_read_b128 v[152:155], v4 offset:8192
    v_max3_u32 v6, v6, v221, v223
    s_waitcnt vmcnt(5)
    v_mfma_f32_16x16x32_bf16 v[40:43], v[180:183], v[224:227], v[40:43]
    s_mov_b32 s58, 13893632
    buffer_load_dwordx4 v[220:223], v11, s[24:27], s58 offen sc1
    v_mfma_f32_16x16x32_bf16 v[44:47], v[184:187], v[224:227], v[44:47]
    ds_read_b128 v[156:159], v4 offset:9216
    v_mfma_f32_16x16x32_bf16 v[48:51], v[188:191], v[224:227], v[48:51]
    ds_read_b128 v[160:163], v4 offset:10240
    v_mfma_f32_16x16x32_bf16 v[52:55], v[192:195], v[224:227], v[52:55]
    ds_read_b128 v[164:167], v4 offset:11264
    v_mfma_f32_16x16x32_bf16 v[56:59], v[196:199], v[224:227], v[56:59]
    ds_read_b128 v[168:171], v4 offset:12288
    v_max3_u32 v6, v6, v225, v227
    s_waitcnt vmcnt(5) lgkmcnt(15)
    v_mfma_f32_16x16x32_bf16 v[40:43], v[60:63], v[200:203], v[40:43]
    s_mov_b32 s58, 14024704
    buffer_load_dwordx4 v[224:227], v11, s[24:27], s58 offen sc1
    v_mfma_f32_16x16x32_bf16 v[44:47], v[64:67], v[200:203], v[44:47]
    ds_read_b128 v[172:175], v4 offset:13312
    v_mfma_f32_16x16x32_bf16 v[48:51], v[68:71], v[200:203], v[48:51]
    ds_read_b128 v[176:179], v4 offset:14336
    v_mfma_f32_16x16x32_bf16 v[52:55], v[72:75], v[200:203], v[52:55]
    ds_read_b128 v[180:183], v4 offset:15360
    v_mfma_f32_16x16x32_bf16 v[56:59], v[76:79], v[200:203], v[56:59]
    ds_read_b128 v[184:187], v4 offset:16384
    v_max3_u32 v6, v6, v201, v203
    s_waitcnt vmcnt(5) lgkmcnt(15)
    v_mfma_f32_16x16x32_bf16 v[40:43], v[80:83], v[204:207], v[40:43]
    s_mov_b32 s58, 14155776
    buffer_load_dwordx4 v[200:203], v11, s[24:27], s58 offen sc1
    v_mfma_f32_16x16x32_bf16 v[44:47], v[84:87], v[204:207], v[44:47]
    ds_read_b128 v[188:191], v4 offset:17408
    v_mfma_f32_16x16x32_bf16 v[48:51], v[88:91], v[204:207], v[48:51]
    ds_read_b128 v[192:195], v4 offset:18432
    v_mfma_f32_16x16x32_bf16 v[52:55], v[92:95], v[204:207], v[52:55]
    ds_read_b128 v[196:199], v4 offset:19456
    v_mfma_f32_16x16x32_bf16 v[56:59], v[96:99], v[204:207], v[56:59]
    ds_read_b128 v[60:63], v4 offset:20480
    v_max3_u32 v6, v6, v205, v207
    s_waitcnt vmcnt(5) lgkmcnt(15)
    v_mfma_f32_16x16x32_bf16 v[40:43], v[100:103], v[208:211], v[40:43]
    s_mov_b32 s58, 14286848
    buffer_load_dwordx4 v[204:207], v11, s[24:27], s58 offen sc1
    v_mfma_f32_16x16x32_bf16 v[44:47], v[104:107], v[208:211], v[44:47]
    ds_read_b128 v[64:67], v4 offset:21504
    v_mfma_f32_16x16x32_bf16 v[48:51], v[108:111], v[208:211], v[48:51]
    ds_read_b128 v[68:71], v4 offset:22528
    v_mfma_f32_16x16x32_bf16 v[52:55], v[112:115], v[208:211], v[52:55]
    ds_read_b128 v[72:75], v4 offset:23552
    v_mfma_f32_16x16x32_bf16 v[56:59], v[116:119], v[208:211], v[56:59]
    ds_read_b128 v[76:79], v4 offset:24576
    v_max3_u32 v6, v6, v209, v211
    s_waitcnt vmcnt(5) lgkmcnt(15)
    v_mfma_f32_16x16x32_bf16 v[40:43], v[120:123], v[212:215], v[40:43]
    s_mov_b32 s58, 14417920
    buffer_load_dwordx4 v[208:211], v11, s[24:27], s58 offen sc1
    v_mfma_f32_16x16x32_bf16 v[44:47], v[124:127], v[212:215], v[44:47]
    ds_read_b128 v[80:83], v4 offset:25600
    v_mfma_f32_16x16x32_bf16 v[48:51], v[128:131], v[212:215], v[48:51]
    ds_read_b128 v[84:87], v4 offset:26624
    v_mfma_f32_16x16x32_bf16 v[52:55], v[132:135], v[212:215], v[52:55]
    ds_read_b128 v[88:91], v4 offset:27648
    v_mfma_f32_16x16x32_bf16 v[56:59], v[136:139], v[212:215], v[56:59]
    ds_read_b128 v[92:95], v4 offset:28672
    v_max3_u32 v6, v6, v213, v215
    s_waitcnt vmcnt(5) lgkmcnt(15)
    v_mfma_f32_16x16x32_bf16 v[40:43], v[140:143], v[216:219], v[40:43]
    s_mov_b32 s58, 14548992
    buffer_load_dwordx4 v[212:215], v11, s[24:27], s58 offen sc1
    v_mfma_f32_16x16x32_bf16 v[44:47], v[144:147], v[216:219], v[44:47]
    ds_read_b128 v[96:99], v4 offset:29696
    v_mfma_f32_16x16x32_bf16 v[48:51], v[148:151], v[216:219], v[48:51]
    ds_read_b128 v[100:103], v4 offset:30720
    v_mfma_f32_16x16x32_bf16 v[52:55], v[152:155], v[216:219], v[52:55]
    ds_read_b128 v[104:107], v4 offset:31744
    v_mfma_f32_16x16x32_bf16 v[56:59], v[156:159], v[216:219], v[56:59]
    ds_read_b128 v[108:111], v4 offset:32768
    v_max3_u32 v6, v6, v217, v219
    s_waitcnt vmcnt(5) lgkmcnt(15)
    v_mfma_f32_16x16x32_bf16 v[40:43], v[160:163], v[220:223], v[40:43]
    s_mov_b32 s58, 14680064
    buffer_load_dwordx4 v[216:219], v11, s[24:27], s58 offen sc1
    v_mfma_f32_16x16x32_bf16 v[44:47], v[164:167], v[220:223], v[44:47]
    ds_read_b128 v[112:115], v4 offset:33792
    v_mfma_f32_16x16x32_bf16 v[48:51], v[168:171], v[220:223], v[48:51]
    ds_read_b128 v[116:119], v4 offset:34816
    v_mfma_f32_16x16x32_bf16 v[52:55], v[172:175], v[220:223], v[52:55]
    ds_read_b128 v[120:123], v4 offset:35840
    v_mfma_f32_16x16x32_bf16 v[56:59], v[176:179], v[220:223], v[56:59]
    ds_read_b128 v[124:127], v4 offset:36864
    v_max3_u32 v6, v6, v221, v223
    s_waitcnt vmcnt(5) lgkmcnt(15)
    v_mfma_f32_16x16x32_bf16 v[40:43], v[180:183], v[224:227], v[40:43]
    s_mov_b32 s58, 14811136
    buffer_load_dwordx4 v[220:223], v11, s[24:27], s58 offen sc1
    v_mfma_f32_16x16x32_bf16 v[44:47], v[184:187], v[224:227], v[44:47]
    ds_read_b128 v[128:131], v4 offset:37888
    v_mfma_f32_16x16x32_bf16 v[48:51], v[188:191], v[224:227], v[48:51]
    ds_read_b128 v[132:135], v4 offset:38912
    v_mfma_f32_16x16x32_bf16 v[52:55], v[192:195], v[224:227], v[52:55]
    ds_read_b128 v[136:139], v4 offset:39936
    v_mfma_f32_16x16x32_bf16 v[56:59], v[196:199], v[224:227], v[56:59]
    ds_read_b128 v[140:143], v4 offset:40960
    v_max3_u32 v6, v6, v225, v227
    s_waitcnt vmcnt(5) lgkmcnt(15)
    v_mfma_f32_16x16x32_bf16 v[40:43], v[60:63], v[200:203], v[40:43]
    v_mfma_f32_16x16x32_bf16 v[44:47], v[64:67], v[200:203], v[44:47]
    ds_read_b128 v[144:147], v4 offset:41984
    v_mfma_f32_16x16x32_bf16 v[48:51], v[68:71], v[200:203], v[48:51]
    ds_read_b128 v[148:151], v4 offset:43008
    v_mfma_f32_16x16x32_bf16 v[52:55], v[72:75], v[200:203], v[52:55]
    ds_read_b128 v[152:155], v4 offset:44032
    v_mfma_f32_16x16x32_bf16 v[56:59], v[76:79], v[200:203], v[56:59]
    ds_read_b128 v[156:159], v4 offset:45056
    v_max3_u32 v6, v6, v201, v203
    s_waitcnt vmcnt(4) lgkmcnt(15)
    v_mfma_f32_16x16x32_bf16 v[40:43], v[80:83], v[204:207], v[40:43]
    v_mfma_f32_16x16x32_bf16 v[44:47], v[84:87], v[204:207], v[44:47]
    ds_read_b128 v[160:163], v4 offset:46080
    v_mfma_f32_16x16x32_bf16 v[48:51], v[88:91], v[204:207], v[48:51]
    ds_read_b128 v[164:167], v4 offset:47104
    v_mfma_f32_16x16x32_bf16 v[52:55], v[92:95], v[204:207], v[52:55]
    ds_read_b128 v[168:171], v4 offset:48128
    v_mfma_f32_16x16x32_bf16 v[56:59], v[96:99], v[204:207], v[56:59]
    ds_read_b128 v[172:175], v4 offset:49152
    v_max3_u32 v6, v6, v205, v207
    s_waitcnt vmcnt(3) lgkmcnt(14)
    v_mfma_f32_16x16x32_bf16 v[40:43], v[100:103], v[208:211], v[40:43]
    v_mfma_f32_16x16x32_bf16 v[44:47], v[104:107], v[208:211], v[44:47]
    ds_read_b128 v[176:179], v4 offset:50176
    v_mfma_f32_16x16x32_bf16 v[48:51], v[108:111], v[208:211], v[48:51]
    v_mfma_f32_16x16x32_bf16 v[52:55], v[112:115], v[208:211], v[52:55]
    v_mfma_f32_16x16x32_bf16 v[56:59], v[116:119], v[208:211], v[56:59]
    v_max3_u32 v6, v6, v209, v211
    s_waitcnt vmcnt(2) lgkmcnt(10)
    v_mfma_f32_16x16x32_bf16 v[40:43], v[120:123], v[212:215], v[40:43]
    v_mfma_f32_16x16x32_bf16 v[44:47], v[124:127], v[212:215], v[44:47]
    v_mfma_f32_16x16x32_bf16 v[48:51], v[128:131], v[212:215], v[48:51]
    v_mfma_f32_16x16x32_bf16 v[52:55], v[132:135], v[212:215], v[52:55]
    v_mfma_f32_16x16x32_bf16 v[56:59], v[136:139], v[212:215], v[56:59]
    v_max3_u32 v6, v6, v213, v215
    s_waitcnt vmcnt(1) lgkmcnt(5)
    v_mfma_f32_16x16x32_bf16 v[40:43], v[140:143], v[216:219], v[40:43]
    v_mfma_f32_16x16x32_bf16 v[44:47], v[144:147], v[216:219], v[44:47]
    v_mfma_f32_16x16x32_bf16 v[48:51], v[148:151], v[216:219], v[48:51]
    v_mfma_f32_16x16x32_bf16 v[52:55], v[152:155], v[216:219], v[52:55]
    v_mfma_f32_16x16x32_bf16 v[56:59], v[156:159], v[216:219], v[56:59]
    v_max3_u32 v6, v6, v217, v219
    s_waitcnt vmcnt(0) lgkmcnt(0)
    v_mfma_f32_16x16x32_bf16 v[40:43], v[160:163], v[220:223], v[40:43]
    v_mfma_f32_16x16x32_bf16 v[44:47], v[164:167], v[220:223], v[44:47]
    v_mfma_f32_16x16x32_bf16 v[48:51], v[168:171], v[220:223], v[48:51]
    v_mfma_f32_16x16x32_bf16 v[52:55], v[172:175], v[220:223], v[52:55]
    v_mfma_f32_16x16x32_bf16 v[56:59], v[176:179], v[220:223], v[56:59]
    v_max3_u32 v6, v6, v221, v223
    v_cmp_eq_u32 vcc, -1, v6
    s_cmp_lt_i32 s69, 0
    s_cbranch_scc1 L_sum
    s_nop 1
    s_cbranch_vccnz L_again
L_sum:
    s_nop 3
    v_pk_add_f32 v[20:21], v[20:21], v[40:41]
    v_pk_add_f32 v[22:23], v[22:23], v[42:43]
    v_pk_add_f32 v[24:25], v[24:25], v[44:45]
    v_pk_add_f32 v[26:27], v[26:27], v[46:47]
    v_pk_add_f32 v[28:29], v[28:29], v[48:49]
    v_pk_add_f32 v[30:31], v[30:31], v[50:51]
    v_pk_add_f32 v[32:33], v[32:33], v[52:53]
    v_pk_add_f32 v[34:35], v[34:35], v[54:55]
    v_pk_add_f32 v[36:37], v[36:37], v[56:57]
    v_pk_add_f32 v[38:39], v[38:39], v[58:59]
    v_cvt_pk_bf16_f32 v220, v20, v21
    v_cvt_pk_bf16_f32 v221, v22, v23
    v_cvt_pk_bf16_f32 v222, v24, v25
    v_cvt_pk_bf16_f32 v223, v26, v27
    v_cvt_pk_bf16_f32 v224, v28, v29
    v_cvt_pk_bf16_f32 v225, v30, v31
    v_cvt_pk_bf16_f32 v226, v32, v33
    v_cvt_pk_bf16_f32 v227, v34, v35
    v_cvt_pk_bf16_f32 v228, v36, v37
    v_cvt_pk_bf16_f32 v229, v38, v39
    buffer_store_dwordx4 v[220:223], v17, s[40:43], 0 offen
    buffer_store_dwordx4 v[224:227], v17, s[40:43], 0 offen offset:64
    buffer_store_dwordx2 v[228:229], v18, s[40:43], 0 offen offset:128
    s_endpgm
L_again:
    s_waitcnt lgkmcnt(10)
    ds_read_b128 v[100:103], v19 offset:10240
    ds_read_b128 v[104:107], v19 offset:11264
    ds_read_b128 v[108:111], v19 offset:12288
    ds_read_b128 v[112:115], v19 offset:13312
    ds_read_b128 v[116:119], v19 offset:14336
    s_waitcnt lgkmcnt(10)
    ds_read_b128 v[120:123], v19 offset:15360
    ds_read_b128 v[124:127], v19 offset:16384
    ds_read_b128 v[128:131], v19 offset:17408
    ds_read_b128 v[132:135], v19 offset:18432
    ds_read_b128 v[136:139], v19 offset:19456
    s_waitcnt lgkmcnt(10)
    ds_read_b128 v[140:143], v19 offset:20480
    ds_read_b128 v[144:147], v19 offset:21504
    ds_read_b128 v[148:151], v19 offset:22528
    ds_read_b128 v[152:155], v19 offset:23552
    ds_read_b128 v[156:159], v19 offset:24576
    s_waitcnt lgkmcnt(10)
    ds_read_b128 v[160:163], v19 offset:25600
    ds_read_b128 v[164:167], v19 offset:26624
    ds_read_b128 v[168:171], v19 offset:27648
    ds_read_b128 v[172:175], v19 offset:28672
    ds_read_b128 v[176:179], v19 offset:29696
    s_branch L_first
L_g0:
    v_lshlrev_b32 v80, 4, v2
    s_mov_b32 s24, s22
    s_mov_b32 s25, s23
    s_mov_b32 s26, 21170304
    s_mov_b32 s27, 0x00020000
    s_mov_b32 s58, 21170176
    s_load_dword s55, s[22:23], s58
    v_and_b32 v2, 15, v1
    v_lshrrev_b32 v3, 4, v1
    v_bfe_u32 v4, v1, 1, 3
    v_xor_b32 v4, v4, v3
    v_lshlrev_b32 v4, 4, v4
    v_lshl_add_u32 v4, v2, 7, v4
    s_and_b32 s58, s45, 1
    s_lshl_b32 s58, s58, 13
    v_add_u32 v11, s58, v4
    v_xor_b32 v12, 64, v11
    v_bfe_u32 v4, v1, 2, 2
    v_lshl_add_u32 v5, v3, 3, v4
    v_lshlrev_b32 v5, 8, v5
    v_bfe_u32 v4, v1, 2, 3
    s_lshr_b32 s58, s45, 1
    s_lshl_b32 s58, s58, 2
    v_xor_b32 v4, s58, v4
    v_lshl_add_u32 v5, v4, 5, v5
    v_and_b32 v4, 3, v1
    v_lshl_add_u32 v13, v4, 3, v5
    v_xor_b32 v14, 32, v13
    v_xor_b32 v15, 64, v13
    v_xor_b32 v16, 96, v13
    v_mov_b64 v[96:97], 0
    v_mov_b64 v[98:99], 0
    v_mov_b64 v[100:101], 0
    v_mov_b64 v[102:103], 0
    v_mov_b64 v[104:105], 0
    v_mov_b64 v[106:107], 0
    v_mov_b64 v[108:109], 0
    v_mov_b64 v[110:111], 0
    v_mov_b64 v[112:113], 0
    v_mov_b64 v[114:115], 0
    v_mov_b64 v[116:117], 0
    v_mov_b64 v[118:119], 0
    v_mov_b64 v[120:121], 0
    v_mov_b64 v[122:123], 0
    v_mov_b64 v[124:125], 0
    v_mov_b64 v[126:127], 0
    v_mov_b64 v[128:129], 0
    v_mov_b64 v[130:131], 0
    v_mov_b64 v[132:133], 0
    v_mov_b64 v[134:135], 0
    v_mov_b64 v[136:137], 0
    v_mov_b64 v[138:139], 0
    v_mov_b64 v[140:141], 0
    v_mov_b64 v[142:143], 0
    v_mov_b64 v[144:145], 0
    v_mov_b64 v[146:147], 0
    v_mov_b64 v[148:149], 0
    v_mov_b64 v[150:151], 0
    v_mov_b64 v[152:153], 0
    v_mov_b64 v[154:155], 0
    v_mov_b64 v[156:157], 0
    v_mov_b64 v[158:159], 0
    v_mov_b64 v[160:161], 0
    v_mov_b64 v[162:163], 0
    v_mov_b64 v[164:165], 0
    v_mov_b64 v[166:167], 0
    v_mov_b64 v[168:169], 0
    v_mov_b64 v[170:171], 0
    v_mov_b64 v[172:173], 0
    v_mov_b64 v[174:175], 0
    v_mov_b64 v[176:177], 0
    v_mov_b64 v[178:179], 0
    v_mov_b64 v[180:181], 0
    v_mov_b64 v[182:183], 0
    v_mov_b64 v[184:185], 0
    v_mov_b64 v[186:187], 0
    v_mov_b64 v[188:189], 0
    v_mov_b64 v[190:191], 0
    v_mov_b64 v[192:193], 0
    v_mov_b64 v[194:195], 0
    v_mov_b64 v[196:197], 0
    v_mov_b64 v[198:199], 0
    v_mov_b64 v[200:201], 0
    v_mov_b64 v[202:203], 0
    v_mov_b64 v[204:205], 0
    v_mov_b64 v[206:207], 0
    v_mov_b64 v[208:209], 0
    v_mov_b64 v[210:211], 0
    v_mov_b64 v[212:213], 0
    v_mov_b64 v[214:215], 0
    v_mov_b64 v[216:217], 0
    v_mov_b64 v[218:219], 0
    v_mov_b64 v[220:221], 0
    v_mov_b64 v[222:223], 0
    s_and_b32 s58, s2, 7
    s_lshr_b32 s59, s2, 3
    s_and_b32 s60, s59, 3
    s_lshl_b32 s48, s58, 2
    s_add_u32 s48, s48, s60
    s_lshr_b32 s49, s59, 2
    s_and_b32 s54, s48, 1
    s_lshr_b32 s60, s48, 1
    s_mul_i32 s60, s60, 5
    s_add_u32 s53, s60, 2
    s_mul_i32 s61, s54, 3
    s_add_u32 s52, s60, s61
    s_lshl_b32 s52, s52, 15
    s_lshl_b32 s53, s53, 15
    v_and_b32 v2, 15, v1
    v_lshrrev_b32 v3, 4, v1
    s_lshr_b32 s58, s45, 1
    s_lshl_b32 s58, s58, 8
    s_add_u32 s58, s58, 147456
    v_lshl_add_u32 v8, v3, 4, s58
    s_and_b32 s59, s45, 1
    s_lshl_b32 s58, s59, 8
    s_add_u32 s58, s58, 147456
    v_lshl_add_u32 v9, v2, 2, s58
    v_bfrev_b32 v3, v3
    v_lshrrev_b32 v3, 15, v3
    v_lshl_add_u32 v3, v2, 4, v3
    s_lshl_b32 s58, s46, 1
    s_add_u32 s58, s58, s59
    s_lshl_b32 s58, s58, 10
    v_add_u32 v10, s58, v3
    v_mov_b32 v17, v8
    v_mov_b32 v19, v10
    s_cmp_lt_u32 s47, 10
    s_cbranch_scc1 L_ad_j
    v_lshrrev_b32 v3, 4, v1
    s_lshl_b32 s58, s59, 8
    s_add_u32 s58, s58, 147456
    v_lshl_add_u32 v17, v3, 4, s58
    s_lshr_b32 s60, s45, 1
    s_lshl_b32 s58, s60, 8
    s_add_u32 s58, s58, 148480
    v_lshl_add_u32 v18, v2, 2, s58
    s_sub_u32 s58, s47, 10
    s_lshl_b32 s58, s58, 1
    s_add_u32 s58, s58, s60
    s_lshl_b32 s58, s58, 10
    v_mul_u32_u24 v3, 10240, v3
    v_lshl_add_u32 v3, v2, 4, v3
    v_add_u32 v19, s58, v3
L_ad_j:
    v_and_b32 v2, 31, v1
    v_lshrrev_b32 v3, 5, v1
    s_lshl_b32 s58, s49, 2
    s_add_u32 s58, s58, s45
    s_lshl_b32 s58, s58, 10
    s_lshl_b32 s59, s54, 3
    s_add_u32 s60, s58, s59
    v_lshlrev_b32 v4, 4, v2
    v_lshl_add_u32 v24, v3, 15, v4
    v_add_u32 v24, s58, v24
    v_add_u32 v25, s60, v4
    v_mov_b32 v20, 0xdddddddd
    v_lshlrev_b32 v21, 4, v1
    s_mul_i32 s58, s45, 3072
    v_add_u32 v26, s58, v21
    v_add_u32 v21, 95488, v21
    v_add_u32 v22, s59, v21
    v_mad_u32_u24 v4, v3, 20, v2
    v_lshlrev_b32 v4, 4, v4
    v_add_u32 v4, 95488, v4
    v_cmp_gt_u32 vcc, 20, v2
    v_mov_b32 v6, 163840
    v_and_b32 v5, 27, v2
    v_cndmask_b32 v4, v6, v4, vcc
    v_cmp_eq_u32 vcc, 24, v5
    v_mov_b32 v6, 96128
    s_mov_b32 s57, 45568
    v_cndmask_b32 v23, v4, v6, vcc
    v_add_u32 v27, s57, v21
    v_add_u32 v28, s57, v22
    v_add_u32 v29, s57, v23
    s_add_u32 s58, s58, s59
    v_lshl_add_u32 v30, v2, 4, s58
    v_mov_b32 v31, v30
    s_mov_b32 exec_hi, 0
    v_mov_b32 v31, 163840
    s_not_b64 exec, exec
    v_mov_b32 v30, 163840
    s_mov_b64 exec, -1
    v_mov_b32 v84, 0x3f803f80
    s_lshl_b32 s73, s47, 1
    s_lshr_b32 s58, s45, 1
    s_add_u32 s73, s73, s58
    s_lshl1_add_u32 s68, s51, s58
    s_lshl_b32 s70, s73, 4
    s_add_u32 s70, s70, s46
    s_lshl_b32 s70, s70, 1
    s_and_b32 s58, s45, 1
    s_add_u32 s70, s70, s58
    s_mov_b32 s56, 0
    s_mov_b32 s64, 0
    s_mov_b32 s65, 49152
    s_waitcnt lgkmcnt(0)
    s_add_u32 s55, s55, 1
    s_cmp_ge_u32 s45, s75
    s_cbranch_scc1 L_st_m
    v_mov_b32 v72, 0
    v_mov_b32 v74, 0
    v_mov_b32 v73, s55
    v_mov_b32 v75, s55
    s_waitcnt vmcnt(4)
    v_dot2c_f32_bf16 v72, v32, v84
    v_dot2c_f32_bf16 v74, v32, v32
    v_dot2c_f32_bf16 v72, v33, v84
    v_dot2c_f32_bf16 v74, v33, v33
    v_dot2c_f32_bf16 v72, v34, v84
    v_dot2c_f32_bf16 v74, v34, v34
    v_dot2c_f32_bf16 v72, v35, v84
    v_dot2c_f32_bf16 v74, v35, v35
    s_waitcnt vmcnt(3)
    v_dot2c_f32_bf16 v72, v36, v84
    v_dot2c_f32_bf16 v74, v36, v36
    v_dot2c_f32_bf16 v72, v37, v84
    v_dot2c_f32_bf16 v74, v37, v37
    v_dot2c_f32_bf16 v72, v38, v84
    v_dot2c_f32_bf16 v74, v38, v38
    v_dot2c_f32_bf16 v72, v39, v84
    v_dot2c_f32_bf16 v74, v39, v39
    s_waitcnt vmcnt(2)
    v_dot2c_f32_bf16 v72, v40, v84
    v_dot2c_f32_bf16 v74, v40, v40
    v_dot2c_f32_bf16 v72, v41, v84
    v_dot2c_f32_bf16 v74, v41, v41
    v_dot2c_f32_bf16 v72, v42, v84
    v_dot2c_f32_bf16 v74, v42, v42
    v_dot2c_f32_bf16 v72, v43, v84
    v_dot2c_f32_bf16 v74, v43, v43
    s_waitcnt vmcnt(1)
    v_dot2c_f32_bf16 v72, v44, v84
    v_dot2c_f32_bf16 v74, v44, v44
    v_dot2c_f32_bf16 v72, v45, v84
    v_dot2c_f32_bf16 v74, v45, v45
    v_dot2c_f32_bf16 v72, v46, v84
    v_dot2c_f32_bf16 v74, v46, v46
    v_dot2c_f32_bf16 v72, v47, v84
    v_dot2c_f32_bf16 v74, v47, v47
    s_waitcnt vmcnt(0)
    v_dot2c_f32_bf16 v72, v48, v84
    v_dot2c_f32_bf16 v74, v48, v48
    v_dot2c_f32_bf16 v72, v49, v84
    v_dot2c_f32_bf16 v74, v49, v49
    v_dot2c_f32_bf16 v72, v50, v84
    v_dot2c_f32_bf16 v74, v50, v50
    v_dot2c_f32_bf16 v72, v51, v84
    v_dot2c_f32_bf16 v74, v51, v51
    s_nop 1
    s_nop 0
    v_add_f32_dpp v72, v72, v72 row_ror:8 row_mask:0xf bank_mask:0xf
    v_add_f32_dpp v74, v74, v74 row_ror:8 row_mask:0xf bank_mask:0xf
    s_nop 0
    v_add_f32_dpp v72, v72, v72 row_ror:4 row_mask:0xf bank_mask:0xf
    v_add_f32_dpp v74, v74, v74 row_ror:4 row_mask:0xf bank_mask:0xf
    s_nop 0
    v_add_f32_dpp v72, v72, v72 row_ror:2 row_mask:0xf bank_mask:0xf
    v_add_f32_dpp v74, v74, v74 row_ror:2 row_mask:0xf bank_mask:0xf
    s_nop 0
    v_add_f32_dpp v72, v72, v72 row_ror:1 row_mask:0xf bank_mask:0xf
    v_add_f32_dpp v74, v74, v74 row_ror:1 row_mask:0xf bank_mask:0xf
    v_mul_f32 v72, 3133983949, v72
    v_mul_f32 v74, 986500301, v74
    v_fma_f32 v74, -v72, v72, v74
    v_max_f32 v74, 0, v74
    v_add_f32 v74, 925353388, v74
    v_rsq_f32 v74, v74
    s_lshl_b32 s58, s45, 6
    s_add_u32 s58, s58, 151040
    v_add_u32 v4, s58, v80
    s_mov_b32 exec_lo, 0x00010001
    s_mov_b32 exec_hi, 0x00010001
    ds_write_b128 v4, v[72:75]
    s_mov_b64 exec, -1
    s_waitcnt lgkmcnt(0)
L_st_m:
    s_cmp_eq_u32 s47, 15
    s_cbranch_scc1 L_tr
    s_barrier
    ds_read_b64_tr_b16 v[64:65], v13 offset:16384
    ds_read_b64_tr_b16 v[66:67], v13 offset:17408
    ds_read_b128 v[32:35], v11 offset:0
    ds_read_b64_tr_b16 v[68:69], v14 offset:16384
    ds_read_b64_tr_b16 v[70:71], v14 offset:17408
    ds_read_b64_tr_b16 v[72:73], v15 offset:16384
    ds_read_b64_tr_b16 v[74:75], v15 offset:17408
    ds_read_b64_tr_b16 v[76:77], v16 offset:16384
    ds_read_b64_tr_b16 v[78:79], v16 offset:17408
    ds_read_b128 v[36:39], v11 offset:2048
    ds_read_b128 v[40:43], v11 offset:4096
    ds_read_b128 v[44:47], v11 offset:6144
    s_cmp_ge_u32 s47, 10
    s_waitcnt lgkmcnt(0)
    s_cbranch_scc0 L_aN
    s_cmp_ge_u32 s68, 27
    s_cbranch_scc1 L_sV
.p2align 3
L_jV:
    v_mfma_f32_16x16x32_bf16 v[96:99], v[32:35], v[64:67], v[96:99]
    ds_read_b64_tr_b16 v[80:81], v13 offset:32768
    v_mfma_f32_16x16x32_bf16 v[100:103], v[32:35], v[68:71], v[100:103]
    ds_read_b64_tr_b16 v[82:83], v13 offset:33792
    v_mfma_f32_16x16x32_bf16 v[104:107], v[32:35], v[72:75], v[104:107]
    ds_read_b64_tr_b16 v[84:85], v14 offset:32768
    v_mfma_f32_16x16x32_bf16 v[108:111], v[32:35], v[76:79], v[108:111]
    ds_read_b64_tr_b16 v[86:87], v14 offset:33792
    v_mfma_f32_16x16x32_bf16 v[112:115], v[36:39], v[64:67], v[112:115]
    ds_read_b64_tr_b16 v[88:89], v15 offset:32768
    v_mfma_f32_16x16x32_bf16 v[116:119], v[36:39], v[68:71], v[116:119]
    ds_read_b64_tr_b16 v[90:91], v15 offset:33792
    v_mfma_f32_16x16x32_bf16 v[120:123], v[36:39], v[72:75], v[120:123]
    ds_read_b64_tr_b16 v[92:93], v16 offset:32768
    v_mfma_f32_16x16x32_bf16 v[124:127], v[36:39], v[76:79], v[124:127]
    ds_read_b64_tr_b16 v[94:95], v16 offset:33792
    v_mfma_f32_16x16x32_bf16 v[128:131], v[40:43], v[64:67], v[128:131]
    v_mfma_f32_16x16x32_bf16 v[132:135], v[40:43], v[68:71], v[132:135]
    v_mfma_f32_16x16x32_bf16 v[136:139], v[40:43], v[72:75], v[136:139]
    v_mfma_f32_16x16x32_bf16 v[140:143], v[40:43], v[76:79], v[140:143]
    v_mfma_f32_16x16x32_bf16 v[144:147], v[44:47], v[64:67], v[144:147]
    v_mfma_f32_16x16x32_bf16 v[148:151], v[44:47], v[68:71], v[148:151]
    v_mfma_f32_16x16x32_bf16 v[152:155], v[44:47], v[72:75], v[152:155]
    v_mfma_f32_16x16x32_bf16 v[156:159], v[44:47], v[76:79], v[156:159]
    s_waitcnt lgkmcnt(0)
    v_mfma_f32_16x16x32_bf16 v[160:163], v[80:83], v[32:35], v[160:163]
    ds_read_b64_tr_b16 v[64:65], v13 offset:24576
    v_mfma_f32_16x16x32_bf16 v[164:167], v[84:87], v[32:35], v[164:167]
    ds_read_b64_tr_b16 v[66:67], v13 offset:25600
    v_mfma_f32_16x16x32_bf16 v[168:171], v[88:91], v[32:35], v[168:171]
    ds_read_b128 v[48:51], v12 offset:0
    v_mfma_f32_16x16x32_bf16 v[172:175], v[92:95], v[32:35], v[172:175]
    ds_read_b64_tr_b16 v[68:69], v14 offset:24576
    v_mfma_f32_16x16x32_bf16 v[176:179], v[80:83], v[36:39], v[176:179]
    ds_read_b64_tr_b16 v[70:71], v14 offset:25600
    v_mfma_f32_16x16x32_bf16 v[180:183], v[84:87], v[36:39], v[180:183]
    ds_read_b64_tr_b16 v[72:73], v15 offset:24576
    v_mfma_f32_16x16x32_bf16 v[184:187], v[88:91], v[36:39], v[184:187]
    ds_read_b64_tr_b16 v[74:75], v15 offset:25600
    v_mfma_f32_16x16x32_bf16 v[188:191], v[92:95], v[36:39], v[188:191]
    ds_read_b64_tr_b16 v[76:77], v16 offset:24576
    v_mfma_f32_16x16x32_bf16 v[192:195], v[80:83], v[40:43], v[192:195]
    ds_read_b64_tr_b16 v[78:79], v16 offset:25600
    v_mfma_f32_16x16x32_bf16 v[196:199], v[84:87], v[40:43], v[196:199]
    ds_read_b128 v[52:55], v12 offset:2048
    v_mfma_f32_16x16x32_bf16 v[200:203], v[88:91], v[40:43], v[200:203]
    ds_read_b128 v[56:59], v12 offset:4096
    v_mfma_f32_16x16x32_bf16 v[204:207], v[92:95], v[40:43], v[204:207]
    ds_read_b128 v[60:63], v12 offset:6144
    v_mfma_f32_16x16x32_bf16 v[208:211], v[80:83], v[44:47], v[208:211]
    v_mfma_f32_16x16x32_bf16 v[212:215], v[84:87], v[44:47], v[212:215]
    v_mfma_f32_16x16x32_bf16 v[216:219], v[88:91], v[44:47], v[216:219]
    v_mfma_f32_16x16x32_bf16 v[220:223], v[92:95], v[44:47], v[220:223]
    s_waitcnt lgkmcnt(0)
    v_mfma_f32_16x16x32_bf16 v[96:99], v[48:51], v[64:67], v[96:99]
    ds_read_b64_tr_b16 v[80:81], v13 offset:40960
    v_mfma_f32_16x16x32_bf16 v[100:103], v[48:51], v[68:71], v[100:103]
    ds_read_b64_tr_b16 v[82:83], v13 offset:41984
    v_mfma_f32_16x16x32_bf16 v[104:107], v[48:51], v[72:75], v[104:107]
    ds_read_b64_tr_b16 v[84:85], v14 offset:40960
    v_mfma_f32_16x16x32_bf16 v[108:111], v[48:51], v[76:79], v[108:111]
    ds_read_b64_tr_b16 v[86:87], v14 offset:41984
    v_mfma_f32_16x16x32_bf16 v[112:115], v[52:55], v[64:67], v[112:115]
    ds_read_b64_tr_b16 v[88:89], v15 offset:40960
    v_mfma_f32_16x16x32_bf16 v[116:119], v[52:55], v[68:71], v[116:119]
    ds_read_b64_tr_b16 v[90:91], v15 offset:41984
    v_mfma_f32_16x16x32_bf16 v[120:123], v[52:55], v[72:75], v[120:123]
    ds_read_b64_tr_b16 v[92:93], v16 offset:40960
    v_mfma_f32_16x16x32_bf16 v[124:127], v[52:55], v[76:79], v[124:127]
    ds_read_b64_tr_b16 v[94:95], v16 offset:41984
    v_mfma_f32_16x16x32_bf16 v[128:131], v[56:59], v[64:67], v[128:131]
    s_add_u32 s64, s64, 1
    v_mfma_f32_16x16x32_bf16 v[132:135], v[56:59], v[68:71], v[132:135]
    s_cmp_eq_u32 s64, 3
    v_mfma_f32_16x16x32_bf16 v[136:139], v[56:59], v[72:75], v[136:139]
    s_cselect_b32 s62, 4294868992, s65
    v_mfma_f32_16x16x32_bf16 v[140:143], v[56:59], v[76:79], v[140:143]
    s_cselect_b32 s64, 0, s64
    v_mfma_f32_16x16x32_bf16 v[144:147], v[60:63], v[64:67], v[144:147]
    v_add_u32 v11, s62, v11
    v_add_u32 v12, s62, v12
    v_mfma_f32_16x16x32_bf16 v[148:151], v[60:63], v[68:71], v[148:151]
    v_add_u32 v13, s62, v13
    v_add_u32 v14, s62, v14
    v_mfma_f32_16x16x32_bf16 v[152:155], v[60:63], v[72:75], v[152:155]
    v_add_u32 v15, s62, v15
    v_add_u32 v16, s62, v16
    v_mfma_f32_16x16x32_bf16 v[156:159], v[60:63], v[76:79], v[156:159]
    s_waitcnt lgkmcnt(0)
    v_mfma_f32_16x16x32_bf16 v[160:163], v[80:83], v[48:51], v[160:163]
    s_barrier
    ds_read_b64_tr_b16 v[64:65], v13 offset:16384
    v_mfma_f32_16x16x32_bf16 v[164:167], v[84:87], v[48:51], v[164:167]
    ds_read_b64_tr_b16 v[66:67], v13 offset:17408
    v_mfma_f32_16x16x32_bf16 v[168:171], v[88:91], v[48:51], v[168:171]
    ds_read_b128 v[32:35], v11 offset:0
    v_mfma_f32_16x16x32_bf16 v[172:175], v[92:95], v[48:51], v[172:175]
    ds_read_b64_tr_b16 v[68:69], v14 offset:16384
    v_mfma_f32_16x16x32_bf16 v[176:179], v[80:83], v[52:55], v[176:179]
    ds_read_b64_tr_b16 v[70:71], v14 offset:17408
    v_mfma_f32_16x16x32_bf16 v[180:183], v[84:87], v[52:55], v[180:183]
    ds_read_b64_tr_b16 v[72:73], v15 offset:16384
    v_mfma_f32_16x16x32_bf16 v[184:187], v[88:91], v[52:55], v[184:187]
    ds_read_b64_tr_b16 v[74:75], v15 offset:17408
    v_mfma_f32_16x16x32_bf16 v[188:191], v[92:95], v[52:55], v[188:191]
    ds_read_b64_tr_b16 v[76:77], v16 offset:16384
    v_mfma_f32_16x16x32_bf16 v[192:195], v[80:83], v[56:59], v[192:195]
    ds_read_b64_tr_b16 v[78:79], v16 offset:17408
    v_mfma_f32_16x16x32_bf16 v[196:199], v[84:87], v[56:59], v[196:199]
    ds_read_b128 v[36:39], v11 offset:2048
    v_mfma_f32_16x16x32_bf16 v[200:203], v[88:91], v[56:59], v[200:203]
    ds_read_b128 v[40:43], v11 offset:4096
    v_mfma_f32_16x16x32_bf16 v[204:207], v[92:95], v[56:59], v[204:207]
    ds_read_b128 v[44:47], v11 offset:6144
    v_mfma_f32_16x16x32_bf16 v[208:211], v[80:83], v[60:63], v[208:211]
    v_mfma_f32_16x16x32_bf16 v[212:215], v[84:87], v[60:63], v[212:215]
    s_add_u32 s56, s56, 1
    v_mfma_f32_16x16x32_bf16 v[216:219], v[88:91], v[60:63], v[216:219]
    s_cmp_lt_u32 s56, 7
    v_mfma_f32_16x16x32_bf16 v[220:223], v[92:95], v[60:63], v[220:223]
    s_waitcnt lgkmcnt(0)
    s_cbranch_scc1 L_jV
.p2align 3
L_sV:
    v_mfma_f32_16x16x32_bf16 v[96:99], v[32:35], v[64:67], v[96:99]
    ds_read_b64_tr_b16 v[80:81], v13 offset:24576
    v_mfma_f32_16x16x32_bf16 v[100:103], v[32:35], v[68:71], v[100:103]
    ds_read_b64_tr_b16 v[82:83], v13 offset:25600
    v_mfma_f32_16x16x32_bf16 v[104:107], v[32:35], v[72:75], v[104:107]
    ds_read_b128 v[48:51], v12 offset:0
    v_mfma_f32_16x16x32_bf16 v[108:111], v[32:35], v[76:79], v[108:111]
    ds_read_b64_tr_b16 v[84:85], v14 offset:24576
    v_mfma_f32_16x16x32_bf16 v[112:115], v[36:39], v[64:67], v[112:115]
    ds_read_b64_tr_b16 v[86:87], v14 offset:25600
    v_mfma_f32_16x16x32_bf16 v[116:119], v[36:39], v[68:71], v[116:119]
    ds_read_b64_tr_b16 v[88:89], v15 offset:24576
    v_mfma_f32_16x16x32_bf16 v[120:123], v[36:39], v[72:75], v[120:123]
    ds_read_b64_tr_b16 v[90:91], v15 offset:25600
    v_mfma_f32_16x16x32_bf16 v[124:127], v[36:39], v[76:79], v[124:127]
    ds_read_b64_tr_b16 v[92:93], v16 offset:24576
    v_mfma_f32_16x16x32_bf16 v[128:131], v[40:43], v[64:67], v[128:131]
    s_add_u32 s64, s64, 1
    ds_read_b64_tr_b16 v[94:95], v16 offset:25600
    v_mfma_f32_16x16x32_bf16 v[132:135], v[40:43], v[68:71], v[132:135]
    s_cmp_eq_u32 s64, 3
    ds_read_b128 v[52:55], v12 offset:2048
    v_mfma_f32_16x16x32_bf16 v[136:139], v[40:43], v[72:75], v[136:139]
    s_cselect_b32 s62, 4294868992, s65
    ds_read_b128 v[56:59], v12 offset:4096
    v_mfma_f32_16x16x32_bf16 v[140:143], v[40:43], v[76:79], v[140:143]
    s_cselect_b32 s64, 0, s64
    ds_read_b128 v[60:63], v12 offset:6144
    v_mfma_f32_16x16x32_bf16 v[144:147], v[44:47], v[64:67], v[144:147]
    v_add_u32 v11, s62, v11
    v_add_u32 v12, s62, v12
    v_mfma_f32_16x16x32_bf16 v[148:151], v[44:47], v[68:71], v[148:151]
    v_add_u32 v13, s62, v13
    v_add_u32 v14, s62, v14
    v_mfma_f32_16x16x32_bf16 v[152:155], v[44:47], v[72:75], v[152:155]
    v_add_u32 v15, s62, v15
    v_add_u32 v16, s62, v16
    v_mfma_f32_16x16x32_bf16 v[156:159], v[44:47], v[76:79], v[156:159]
    s_waitcnt lgkmcnt(0)
    v_mfma_f32_16x16x32_bf16 v[96:99], v[48:51], v[80:83], v[96:99]
    s_barrier
    ds_read_b64_tr_b16 v[64:65], v13 offset:16384
    v_mfma_f32_16x16x32_bf16 v[100:103], v[48:51], v[84:87], v[100:103]
    ds_read_b64_tr_b16 v[66:67], v13 offset:17408
    v_mfma_f32_16x16x32_bf16 v[104:107], v[48:51], v[88:91], v[104:107]
    ds_read_b128 v[32:35], v11 offset:0
    v_mfma_f32_16x16x32_bf16 v[108:111], v[48:51], v[92:95], v[108:111]
    ds_read_b64_tr_b16 v[68:69], v14 offset:16384
    v_mfma_f32_16x16x32_bf16 v[112:115], v[52:55], v[80:83], v[112:115]
    ds_read_b64_tr_b16 v[70:71], v14 offset:17408
    v_mfma_f32_16x16x32_bf16 v[116:119], v[52:55], v[84:87], v[116:119]
    ds_read_b64_tr_b16 v[72:73], v15 offset:16384
    v_mfma_f32_16x16x32_bf16 v[120:123], v[52:55], v[88:91], v[120:123]
    ds_read_b64_tr_b16 v[74:75], v15 offset:17408
    v_mfma_f32_16x16x32_bf16 v[124:127], v[52:55], v[92:95], v[124:127]
    ds_read_b64_tr_b16 v[76:77], v16 offset:16384
    v_mfma_f32_16x16x32_bf16 v[128:131], v[56:59], v[80:83], v[128:131]
    ds_read_b64_tr_b16 v[78:79], v16 offset:17408
    v_mfma_f32_16x16x32_bf16 v[132:135], v[56:59], v[84:87], v[132:135]
    ds_read_b128 v[36:39], v11 offset:2048
    v_mfma_f32_16x16x32_bf16 v[136:139], v[56:59], v[88:91], v[136:139]
    ds_read_b128 v[40:43], v11 offset:4096
    v_mfma_f32_16x16x32_bf16 v[140:143], v[56:59], v[92:95], v[140:143]
    ds_read_b128 v[44:47], v11 offset:6144
    v_mfma_f32_16x16x32_bf16 v[144:147], v[60:63], v[80:83], v[144:147]
    v_mfma_f32_16x16x32_bf16 v[148:151], v[60:63], v[84:87], v[148:151]
    s_add_u32 s56, s56, 1
    v_mfma_f32_16x16x32_bf16 v[152:155], v[60:63], v[88:91], v[152:155]
    s_cmp_lt_u32 s56, 9
    v_mfma_f32_16x16x32_bf16 v[156:159], v[60:63], v[92:95], v[156:159]
    s_waitcnt lgkmcnt(0)
    s_cbranch_scc1 L_sV
    s_cmp_eq_u32 s56, 10
    s_cbranch_scc1 L_sVe
    ds_read2_b32 v[4:5], v18 offset0:0 offset1:16
    ds_read2_b32 v[6:7], v18 offset0:32 offset1:48
    ds_read_b128 v[224:227], v17 offset:0
    ds_read_b128 v[228:231], v17 offset:64
    ds_read_b128 v[232:235], v17 offset:128
    ds_read_b128 v[236:239], v17 offset:192
    ds_read_b128 v[240:243], v17 offset:512
    ds_read_b128 v[244:247], v17 offset:576
    ds_read_b128 v[248:251], v17 offset:640
    ds_read_b128 v[252:255], v17 offset:704
    s_branch L_sV
L_sVe:
    s_and_b32 s59, s45, 1
    s_lshl_b32 s58, s46, 1
    s_add_u32 s58, s58, s59
    s_mul_i32 s71, s58, 81920
    s_add_u32 s71, s71, 14942208
    s_add_u32 s72, s71, 40960
    ds_read_b64_tr_b16 v[64:65], v13 offset:32768
    ds_read_b64_tr_b16 v[66:67], v13 offset:33792
    ds_read_b64_tr_b16 v[68:69], v14 offset:32768
    ds_read_b64_tr_b16 v[70:71], v14 offset:33792
    ds_read_b64_tr_b16 v[72:73], v15 offset:32768
    ds_read_b64_tr_b16 v[74:75], v15 offset:33792
    ds_read_b64_tr_b16 v[76:77], v16 offset:32768
    ds_read_b64_tr_b16 v[78:79], v16 offset:33792
    v_pk_fma_f32 v[96:97], v[224:225], v[4:5], v[96:97] op_sel:[0,0,0] op_sel_hi:[1,0,1]
    v_pk_fma_f32 v[98:99], v[226:227], v[4:5], v[98:99] op_sel:[0,0,0] op_sel_hi:[1,0,1]
    v_pk_fma_f32 v[112:113], v[228:229], v[4:5], v[112:113] op_sel:[0,0,0] op_sel_hi:[1,0,1]
    v_pk_fma_f32 v[114:115], v[230:231], v[4:5], v[114:115] op_sel:[0,0,0] op_sel_hi:[1,0,1]
    v_pk_mul_f32 v[96:97], v[96:97], v[240:241]
    v_pk_mul_f32 v[98:99], v[98:99], v[242:243]
    v_pk_mul_f32 v[112:113], v[112:113], v[244:245]
    v_pk_mul_f32 v[114:115], v[114:115], v[246:247]
    v_cvt_pk_bf16_f32 v88, v96, v97
    v_cvt_pk_bf16_f32 v89, v98, v99
    v_cvt_pk_bf16_f32 v90, v112, v113
    v_cvt_pk_bf16_f32 v91, v114, v115
    buffer_store_dwordx4 v[88:91], v19, s[24:27], s71 offen offset:0 sc1
    v_pk_fma_f32 v[100:101], v[224:225], v[4:5], v[100:101] op_sel:[0,1,0] op_sel_hi:[1,1,1]
    v_pk_fma_f32 v[102:103], v[226:227], v[4:5], v[102:103] op_sel:[0,1,0] op_sel_hi:[1,1,1]
    v_pk_fma_f32 v[116:117], v[228:229], v[4:5], v[116:117] op_sel:[0,1,0] op_sel_hi:[1,1,1]
    v_pk_fma_f32 v[118:119], v[230:231], v[4:5], v[118:119] op_sel:[0,1,0] op_sel_hi:[1,1,1]
    v_pk_mul_f32 v[100:101], v[100:101], v[240:241]
    v_pk_mul_f32 v[102:103], v[102:103], v[242:243]
    v_pk_mul_f32 v[116:117], v[116:117], v[244:245]
    v_pk_mul_f32 v[118:119], v[118:119], v[246:247]
    v_cvt_pk_bf16_f32 v92, v100, v101
    v_cvt_pk_bf16_f32 v93, v102, v103
    v_cvt_pk_bf16_f32 v94, v116, v117
    v_cvt_pk_bf16_f32 v95, v118, v119
    buffer_store_dwordx4 v[92:95], v19, s[24:27], s71 offen offset:256 sc1
    v_pk_fma_f32 v[104:105], v[224:225], v[6:7], v[104:105] op_sel:[0,0,0] op_sel_hi:[1,0,1]
    v_pk_fma_f32 v[106:107], v[226:227], v[6:7], v[106:107] op_sel:[0,0,0] op_sel_hi:[1,0,1]
    v_pk_fma_f32 v[120:121], v[228:229], v[6:7], v[120:121] op_sel:[0,0,0] op_sel_hi:[1,0,1]
    v_pk_fma_f32 v[122:123], v[230:231], v[6:7], v[122:123] op_sel:[0,0,0] op_sel_hi:[1,0,1]
    v_pk_mul_f32 v[104:105], v[104:105], v[240:241]
    v_pk_mul_f32 v[106:107], v[106:107], v[242:243]
    v_pk_mul_f32 v[120:121], v[120:121], v[244:245]
    v_pk_mul_f32 v[122:123], v[122:123], v[246:247]
    v_cvt_pk_bf16_f32 v88, v104, v105
    v_cvt_pk_bf16_f32 v89, v106, v107
    v_cvt_pk_bf16_f32 v90, v120, v121
    v_cvt_pk_bf16_f32 v91, v122, v123
    buffer_store_dwordx4 v[88:91], v19, s[24:27], s71 offen offset:512 sc1
    v_pk_fma_f32 v[108:109], v[224:225], v[6:7], v[108:109] op_sel:[0,1,0] op_sel_hi:[1,1,1]
    v_pk_fma_f32 v[110:111], v[226:227], v[6:7], v[110:111] op_sel:[0,1,0] op_sel_hi:[1,1,1]
    v_pk_fma_f32 v[124:125], v[228:229], v[6:7], v[124:125] op_sel:[0,1,0] op_sel_hi:[1,1,1]
    v_pk_fma_f32 v[126:127], v[230:231], v[6:7], v[126:127] op_sel:[0,1,0] op_sel_hi:[1,1,1]
    v_pk_mul_f32 v[108:109], v[108:109], v[240:241]
    v_pk_mul_f32 v[110:111], v[110:111], v[242:243]
    v_pk_mul_f32 v[124:125], v[124:125], v[244:245]
    v_pk_mul_f32 v[126:127], v[126:127], v[246:247]
    v_cvt_pk_bf16_f32 v92, v108, v109
    v_cvt_pk_bf16_f32 v93, v110, v111
    v_cvt_pk_bf16_f32 v94, v124, v125
    v_cvt_pk_bf16_f32 v95, v126, v127
    buffer_store_dwordx4 v[92:95], v19, s[24:27], s71 offen offset:768 sc1
    v_pk_fma_f32 v[128:129], v[232:233], v[4:5], v[128:129] op_sel:[0,0,0] op_sel_hi:[1,0,1]
    v_pk_fma_f32 v[130:131], v[234:235], v[4:5], v[130:131] op_sel:[0,0,0] op_sel_hi:[1,0,1]
    v_pk_fma_f32 v[144:145], v[236:237], v[4:5], v[144:145] op_sel:[0,0,0] op_sel_hi:[1,0,1]
    v_pk_fma_f32 v[146:147], v[238:239], v[4:5], v[146:147] op_sel:[0,0,0] op_sel_hi:[1,0,1]
    v_pk_mul_f32 v[128:129], v[128:129], v[248:249]
    v_pk_mul_f32 v[130:131], v[130:131], v[250:251]
    v_pk_mul_f32 v[144:145], v[144:145], v[252:253]
    v_pk_mul_f32 v[146:147], v[146:147], v[254:255]
    v_cvt_pk_bf16_f32 v88, v128, v129
    v_cvt_pk_bf16_f32 v89, v130, v131
    v_cvt_pk_bf16_f32 v90, v144, v145
    v_cvt_pk_bf16_f32 v91, v146, v147
    buffer_store_dwordx4 v[88:91], v19, s[24:27], s72 offen offset:0 sc1
    v_pk_fma_f32 v[132:133], v[232:233], v[4:5], v[132:133] op_sel:[0,1,0] op_sel_hi:[1,1,1]
    v_pk_fma_f32 v[134:135], v[234:235], v[4:5], v[134:135] op_sel:[0,1,0] op_sel_hi:[1,1,1]
    v_pk_fma_f32 v[148:149], v[236:237], v[4:5], v[148:149] op_sel:[0,1,0] op_sel_hi:[1,1,1]
    v_pk_fma_f32 v[150:151], v[238:239], v[4:5], v[150:151] op_sel:[0,1,0] op_sel_hi:[1,1,1]
    v_pk_mul_f32 v[132:133], v[132:133], v[248:249]
    v_pk_mul_f32 v[134:135], v[134:135], v[250:251]
    v_pk_mul_f32 v[148:149], v[148:149], v[252:253]
    v_pk_mul_f32 v[150:151], v[150:151], v[254:255]
    v_cvt_pk_bf16_f32 v92, v132, v133
    v_cvt_pk_bf16_f32 v93, v134, v135
    v_cvt_pk_bf16_f32 v94, v148, v149
    v_cvt_pk_bf16_f32 v95, v150, v151
    buffer_store_dwordx4 v[92:95], v19, s[24:27], s72 offen offset:256 sc1
    v_pk_fma_f32 v[136:137], v[232:233], v[6:7], v[136:137] op_sel:[0,0,0] op_sel_hi:[1,0,1]
    v_pk_fma_f32 v[138:139], v[234:235], v[6:7], v[138:139] op_sel:[0,0,0] op_sel_hi:[1,0,1]
    v_pk_fma_f32 v[152:153], v[236:237], v[6:7], v[152:153] op_sel:[0,0,0] op_sel_hi:[1,0,1]
    v_pk_fma_f32 v[154:155], v[238:239], v[6:7], v[154:155] op_sel:[0,0,0] op_sel_hi:[1,0,1]
    v_pk_mul_f32 v[136:137], v[136:137], v[248:249]
    v_pk_mul_f32 v[138:139], v[138:139], v[250:251]
    v_pk_mul_f32 v[152:153], v[152:153], v[252:253]
    v_pk_mul_f32 v[154:155], v[154:155], v[254:255]
    v_cvt_pk_bf16_f32 v88, v136, v137
    v_cvt_pk_bf16_f32 v89, v138, v139
    v_cvt_pk_bf16_f32 v90, v152, v153
    v_cvt_pk_bf16_f32 v91, v154, v155
    buffer_store_dwordx4 v[88:91], v19, s[24:27], s72 offen offset:512 sc1
    v_pk_fma_f32 v[140:141], v[232:233], v[6:7], v[140:141] op_sel:[0,1,0] op_sel_hi:[1,1,1]
    v_pk_fma_f32 v[142:143], v[234:235], v[6:7], v[142:143] op_sel:[0,1,0] op_sel_hi:[1,1,1]
    v_pk_fma_f32 v[156:157], v[236:237], v[6:7], v[156:157] op_sel:[0,1,0] op_sel_hi:[1,1,1]
    v_pk_fma_f32 v[158:159], v[238:239], v[6:7], v[158:159] op_sel:[0,1,0] op_sel_hi:[1,1,1]
    v_pk_mul_f32 v[140:141], v[140:141], v[248:249]
    v_pk_mul_f32 v[142:143], v[142:143], v[250:251]
    v_pk_mul_f32 v[156:157], v[156:157], v[252:253]
    v_pk_mul_f32 v[158:159], v[158:159], v[254:255]
    v_cvt_pk_bf16_f32 v92, v140, v141
    v_cvt_pk_bf16_f32 v93, v142, v143
    v_cvt_pk_bf16_f32 v94, v156, v157
    v_cvt_pk_bf16_f32 v95, v158, v159
    buffer_store_dwordx4 v[92:95], v19, s[24:27], s72 offen offset:768 sc1
    s_cmp_ge_u32 s68, 27
    s_cbranch_scc0 L_a_done
L_a_only:
    s_barrier
    s_waitcnt vmcnt(0) lgkmcnt(0)
    s_lshl_b32 s58, s70, 7
    s_add_u32 s58, s58, 20744192
    v_lshlrev_b32 v6, 2, v1
    v_mov_b32 v5, s55
    s_mov_b32 exec_hi, 0
    buffer_store_dword v5, v6, s[24:27], s58 offen sc1
    s_mov_b64 exec, -1
    s_barrier
L_a_none:
    s_mov_b32 s71, 21170304
    s_mov_b32 s72, 21170304
    s_branch L_a_go
L_aN:
    s_cmp_ge_u32 s68, 27
    s_cbranch_scc1 L_sN
.p2align 3
L_jN:
    v_mfma_f32_16x16x32_bf16 v[96:99], v[64:67], v[32:35], v[96:99]
    ds_read_b64_tr_b16 v[80:81], v13 offset:32768
    v_mfma_f32_16x16x32_bf16 v[100:103], v[68:71], v[32:35], v[100:103]
    ds_read_b64_tr_b16 v[82:83], v13 offset:33792
    v_mfma_f32_16x16x32_bf16 v[104:107], v[72:75], v[32:35], v[104:107]
    ds_read_b64_tr_b16 v[84:85], v14 offset:32768
    v_mfma_f32_16x16x32_bf16 v[108:111], v[76:79], v[32:35], v[108:111]
    ds_read_b64_tr_b16 v[86:87], v14 offset:33792
    v_mfma_f32_16x16x32_bf16 v[112:115], v[64:67], v[36:39], v[112:115]
    ds_read_b64_tr_b16 v[88:89], v15 offset:32768
    v_mfma_f32_16x16x32_bf16 v[116:119], v[68:71], v[36:39], v[116:119]
    ds_read_b64_tr_b16 v[90:91], v15 offset:33792
    v_mfma_f32_16x16x32_bf16 v[120:123], v[72:75], v[36:39], v[120:123]
    ds_read_b64_tr_b16 v[92:93], v16 offset:32768
    v_mfma_f32_16x16x32_bf16 v[124:127], v[76:79], v[36:39], v[124:127]
    ds_read_b64_tr_b16 v[94:95], v16 offset:33792
    v_mfma_f32_16x16x32_bf16 v[128:131], v[64:67], v[40:43], v[128:131]
    v_mfma_f32_16x16x32_bf16 v[132:135], v[68:71], v[40:43], v[132:135]
    v_mfma_f32_16x16x32_bf16 v[136:139], v[72:75], v[40:43], v[136:139]
    v_mfma_f32_16x16x32_bf16 v[140:143], v[76:79], v[40:43], v[140:143]
    v_mfma_f32_16x16x32_bf16 v[144:147], v[64:67], v[44:47], v[144:147]
    v_mfma_f32_16x16x32_bf16 v[148:151], v[68:71], v[44:47], v[148:151]
    v_mfma_f32_16x16x32_bf16 v[152:155], v[72:75], v[44:47], v[152:155]
    v_mfma_f32_16x16x32_bf16 v[156:159], v[76:79], v[44:47], v[156:159]
    s_waitcnt lgkmcnt(0)
    v_mfma_f32_16x16x32_bf16 v[160:163], v[80:83], v[32:35], v[160:163]
    ds_read_b64_tr_b16 v[64:65], v13 offset:24576
    v_mfma_f32_16x16x32_bf16 v[164:167], v[84:87], v[32:35], v[164:167]
    ds_read_b64_tr_b16 v[66:67], v13 offset:25600
    v_mfma_f32_16x16x32_bf16 v[168:171], v[88:91], v[32:35], v[168:171]
    ds_read_b128 v[48:51], v12 offset:0
    v_mfma_f32_16x16x32_bf16 v[172:175], v[92:95], v[32:35], v[172:175]
    ds_read_b64_tr_b16 v[68:69], v14 offset:24576
    v_mfma_f32_16x16x32_bf16 v[176:179], v[80:83], v[36:39], v[176:179]
    ds_read_b64_tr_b16 v[70:71], v14 offset:25600
    v_mfma_f32_16x16x32_bf16 v[180:183], v[84:87], v[36:39], v[180:183]
    ds_read_b64_tr_b16 v[72:73], v15 offset:24576
    v_mfma_f32_16x16x32_bf16 v[184:187], v[88:91], v[36:39], v[184:187]
    ds_read_b64_tr_b16 v[74:75], v15 offset:25600
    v_mfma_f32_16x16x32_bf16 v[188:191], v[92:95], v[36:39], v[188:191]
    ds_read_b64_tr_b16 v[76:77], v16 offset:24576
    v_mfma_f32_16x16x32_bf16 v[192:195], v[80:83], v[40:43], v[192:195]
    ds_read_b64_tr_b16 v[78:79], v16 offset:25600
    v_mfma_f32_16x16x32_bf16 v[196:199], v[84:87], v[40:43], v[196:199]
    ds_read_b128 v[52:55], v12 offset:2048
    v_mfma_f32_16x16x32_bf16 v[200:203], v[88:91], v[40:43], v[200:203]
    ds_read_b128 v[56:59], v12 offset:4096
    v_mfma_f32_16x16x32_bf16 v[204:207], v[92:95], v[40:43], v[204:207]
    ds_read_b128 v[60:63], v12 offset:6144
    v_mfma_f32_16x16x32_bf16 v[208:211], v[80:83], v[44:47], v[208:211]
    v_mfma_f32_16x16x32_bf16 v[212:215], v[84:87], v[44:47], v[212:215]
    v_mfma_f32_16x16x32_bf16 v[216:219], v[88:91], v[44:47], v[216:219]
    v_mfma_f32_16x16x32_bf16 v[220:223], v[92:95], v[44:47], v[220:223]
    s_waitcnt lgkmcnt(0)
    v_mfma_f32_16x16x32_bf16 v[96:99], v[64:67], v[48:51], v[96:99]
    ds_read_b64_tr_b16 v[80:81], v13 offset:40960
    v_mfma_f32_16x16x32_bf16 v[100:103], v[68:71], v[48:51], v[100:103]
    ds_read_b64_tr_b16 v[82:83], v13 offset:41984
    v_mfma_f32_16x16x32_bf16 v[104:107], v[72:75], v[48:51], v[104:107]
    ds_read_b64_tr_b16 v[84:85], v14 offset:40960
    v_mfma_f32_16x16x32_bf16 v[108:111], v[76:79], v[48:51], v[108:111]
    ds_read_b64_tr_b16 v[86:87], v14 offset:41984
    v_mfma_f32_16x16x32_bf16 v[112:115], v[64:67], v[52:55], v[112:115]
    ds_read_b64_tr_b16 v[88:89], v15 offset:40960
    v_mfma_f32_16x16x32_bf16 v[116:119], v[68:71], v[52:55], v[116:119]
    ds_read_b64_tr_b16 v[90:91], v15 offset:41984
    v_mfma_f32_16x16x32_bf16 v[120:123], v[72:75], v[52:55], v[120:123]
    ds_read_b64_tr_b16 v[92:93], v16 offset:40960
    v_mfma_f32_16x16x32_bf16 v[124:127], v[76:79], v[52:55], v[124:127]
    ds_read_b64_tr_b16 v[94:95], v16 offset:41984
    v_mfma_f32_16x16x32_bf16 v[128:131], v[64:67], v[56:59], v[128:131]
    s_add_u32 s64, s64, 1
    v_mfma_f32_16x16x32_bf16 v[132:135], v[68:71], v[56:59], v[132:135]
    s_cmp_eq_u32 s64, 3
    v_mfma_f32_16x16x32_bf16 v[136:139], v[72:75], v[56:59], v[136:139]
    s_cselect_b32 s62, 4294868992, s65
    v_mfma_f32_16x16x32_bf16 v[140:143], v[76:79], v[56:59], v[140:143]
    s_cselect_b32 s64, 0, s64
    v_mfma_f32_16x16x32_bf16 v[144:147], v[64:67], v[60:63], v[144:147]
    v_add_u32 v11, s62, v11
    v_add_u32 v12, s62, v12
    v_mfma_f32_16x16x32_bf16 v[148:151], v[68:71], v[60:63], v[148:151]
    v_add_u32 v13, s62, v13
    v_add_u32 v14, s62, v14
    v_mfma_f32_16x16x32_bf16 v[152:155], v[72:75], v[60:63], v[152:155]
    v_add_u32 v15, s62, v15
    v_add_u32 v16, s62, v16
    v_mfma_f32_16x16x32_bf16 v[156:159], v[76:79], v[60:63], v[156:159]
    s_waitcnt lgkmcnt(0)
    v_mfma_f32_16x16x32_bf16 v[160:163], v[80:83], v[48:51], v[160:163]
    s_barrier
    ds_read_b64_tr_b16 v[64:65], v13 offset:16384
    v_mfma_f32_16x16x32_bf16 v[164:167], v[84:87], v[48:51], v[164:167]
    ds_read_b64_tr_b16 v[66:67], v13 offset:17408
    v_mfma_f32_16x16x32_bf16 v[168:171], v[88:91], v[48:51], v[168:171]
    ds_read_b128 v[32:35], v11 offset:0
    v_mfma_f32_16x16x32_bf16 v[172:175], v[92:95], v[48:51], v[172:175]
    ds_read_b64_tr_b16 v[68:69], v14 offset:16384
    v_mfma_f32_16x16x32_bf16 v[176:179], v[80:83], v[52:55], v[176:179]
    ds_read_b64_tr_b16 v[70:71], v14 offset:17408
    v_mfma_f32_16x16x32_bf16 v[180:183], v[84:87], v[52:55], v[180:183]
    ds_read_b64_tr_b16 v[72:73], v15 offset:16384
    v_mfma_f32_16x16x32_bf16 v[184:187], v[88:91], v[52:55], v[184:187]
    ds_read_b64_tr_b16 v[74:75], v15 offset:17408
    v_mfma_f32_16x16x32_bf16 v[188:191], v[92:95], v[52:55], v[188:191]
    ds_read_b64_tr_b16 v[76:77], v16 offset:16384
    v_mfma_f32_16x16x32_bf16 v[192:195], v[80:83], v[56:59], v[192:195]
    ds_read_b64_tr_b16 v[78:79], v16 offset:17408
    v_mfma_f32_16x16x32_bf16 v[196:199], v[84:87], v[56:59], v[196:199]
    ds_read_b128 v[36:39], v11 offset:2048
    v_mfma_f32_16x16x32_bf16 v[200:203], v[88:91], v[56:59], v[200:203]
    ds_read_b128 v[40:43], v11 offset:4096
    v_mfma_f32_16x16x32_bf16 v[204:207], v[92:95], v[56:59], v[204:207]
    ds_read_b128 v[44:47], v11 offset:6144
    v_mfma_f32_16x16x32_bf16 v[208:211], v[80:83], v[60:63], v[208:211]
    v_mfma_f32_16x16x32_bf16 v[212:215], v[84:87], v[60:63], v[212:215]
    s_add_u32 s56, s56, 1
    v_mfma_f32_16x16x32_bf16 v[216:219], v[88:91], v[60:63], v[216:219]
    s_cmp_lt_u32 s56, 7
    v_mfma_f32_16x16x32_bf16 v[220:223], v[92:95], v[60:63], v[220:223]
    s_waitcnt lgkmcnt(0)
    s_cbranch_scc1 L_jN
.p2align 3
L_sN:
    v_mfma_f32_16x16x32_bf16 v[96:99], v[64:67], v[32:35], v[96:99]
    ds_read_b64_tr_b16 v[80:81], v13 offset:24576
    v_mfma_f32_16x16x32_bf16 v[100:103], v[68:71], v[32:35], v[100:103]
    ds_read_b64_tr_b16 v[82:83], v13 offset:25600
    v_mfma_f32_16x16x32_bf16 v[104:107], v[72:75], v[32:35], v[104:107]
    ds_read_b128 v[48:51], v12 offset:0
    v_mfma_f32_16x16x32_bf16 v[108:111], v[76:79], v[32:35], v[108:111]
    ds_read_b64_tr_b16 v[84:85], v14 offset:24576
    v_mfma_f32_16x16x32_bf16 v[112:115], v[64:67], v[36:39], v[112:115]
    ds_read_b64_tr_b16 v[86:87], v14 offset:25600
    v_mfma_f32_16x16x32_bf16 v[116:119], v[68:71], v[36:39], v[116:119]
    ds_read_b64_tr_b16 v[88:89], v15 offset:24576
    v_mfma_f32_16x16x32_bf16 v[120:123], v[72:75], v[36:39], v[120:123]
    ds_read_b64_tr_b16 v[90:91], v15 offset:25600
    v_mfma_f32_16x16x32_bf16 v[124:127], v[76:79], v[36:39], v[124:127]
    ds_read_b64_tr_b16 v[92:93], v16 offset:24576
    v_mfma_f32_16x16x32_bf16 v[128:131], v[64:67], v[40:43], v[128:131]
    s_add_u32 s64, s64, 1
    ds_read_b64_tr_b16 v[94:95], v16 offset:25600
    v_mfma_f32_16x16x32_bf16 v[132:135], v[68:71], v[40:43], v[132:135]
    s_cmp_eq_u32 s64, 3
    ds_read_b128 v[52:55], v12 offset:2048
    v_mfma_f32_16x16x32_bf16 v[136:139], v[72:75], v[40:43], v[136:139]
    s_cselect_b32 s62, 4294868992, s65
    ds_read_b128 v[56:59], v12 offset:4096
    v_mfma_f32_16x16x32_bf16 v[140:143], v[76:79], v[40:43], v[140:143]
    s_cselect_b32 s64, 0, s64
    ds_read_b128 v[60:63], v12 offset:6144
    v_mfma_f32_16x16x32_bf16 v[144:147], v[64:67], v[44:47], v[144:147]
    v_add_u32 v11, s62, v11
    v_add_u32 v12, s62, v12
    v_mfma_f32_16x16x32_bf16 v[148:151], v[68:71], v[44:47], v[148:151]
    v_add_u32 v13, s62, v13
    v_add_u32 v14, s62, v14
    v_mfma_f32_16x16x32_bf16 v[152:155], v[72:75], v[44:47], v[152:155]
    v_add_u32 v15, s62, v15
    v_add_u32 v16, s62, v16
    v_mfma_f32_16x16x32_bf16 v[156:159], v[76:79], v[44:47], v[156:159]
    s_waitcnt lgkmcnt(0)
    v_mfma_f32_16x16x32_bf16 v[96:99], v[80:83], v[48:51], v[96:99]
    s_barrier
    ds_read_b64_tr_b16 v[64:65], v13 offset:16384
    v_mfma_f32_16x16x32_bf16 v[100:103], v[84:87], v[48:51], v[100:103]
    ds_read_b64_tr_b16 v[66:67], v13 offset:17408
    v_mfma_f32_16x16x32_bf16 v[104:107], v[88:91], v[48:51], v[104:107]
    ds_read_b128 v[32:35], v11 offset:0
    v_mfma_f32_16x16x32_bf16 v[108:111], v[92:95], v[48:51], v[108:111]
    ds_read_b64_tr_b16 v[68:69], v14 offset:16384
    v_mfma_f32_16x16x32_bf16 v[112:115], v[80:83], v[52:55], v[112:115]
    ds_read_b64_tr_b16 v[70:71], v14 offset:17408
    v_mfma_f32_16x16x32_bf16 v[116:119], v[84:87], v[52:55], v[116:119]
    ds_read_b64_tr_b16 v[72:73], v15 offset:16384
    v_mfma_f32_16x16x32_bf16 v[120:123], v[88:91], v[52:55], v[120:123]
    ds_read_b64_tr_b16 v[74:75], v15 offset:17408
    v_mfma_f32_16x16x32_bf16 v[124:127], v[92:95], v[52:55], v[124:127]
    ds_read_b64_tr_b16 v[76:77], v16 offset:16384
    v_mfma_f32_16x16x32_bf16 v[128:131], v[80:83], v[56:59], v[128:131]
    ds_read_b64_tr_b16 v[78:79], v16 offset:17408
    v_mfma_f32_16x16x32_bf16 v[132:135], v[84:87], v[56:59], v[132:135]
    ds_read_b128 v[36:39], v11 offset:2048
    v_mfma_f32_16x16x32_bf16 v[136:139], v[88:91], v[56:59], v[136:139]
    ds_read_b128 v[40:43], v11 offset:4096
    v_mfma_f32_16x16x32_bf16 v[140:143], v[92:95], v[56:59], v[140:143]
    ds_read_b128 v[44:47], v11 offset:6144
    v_mfma_f32_16x16x32_bf16 v[144:147], v[80:83], v[60:63], v[144:147]
    v_mfma_f32_16x16x32_bf16 v[148:151], v[84:87], v[60:63], v[148:151]
    s_add_u32 s56, s56, 1
    v_mfma_f32_16x16x32_bf16 v[152:155], v[88:91], v[60:63], v[152:155]
    s_cmp_lt_u32 s56, 9
    v_mfma_f32_16x16x32_bf16 v[156:159], v[92:95], v[60:63], v[156:159]
    s_waitcnt lgkmcnt(0)
    s_cbranch_scc1 L_sN
    s_cmp_eq_u32 s56, 10
    s_cbranch_scc1 L_sNe
    ds_read_b128 v[224:227], v17 offset:1024
    ds_read_b128 v[228:231], v17 offset:1088
    ds_read_b128 v[232:235], v17 offset:1152
    ds_read_b128 v[236:239], v17 offset:1216
    ds_read2_b32 v[240:241], v9 offset0:0 offset1:128
    ds_read2_b32 v[242:243], v9 offset0:16 offset1:144
    ds_read2_b32 v[244:245], v9 offset0:32 offset1:160
    ds_read2_b32 v[246:247], v9 offset0:48 offset1:176
    s_branch L_sN
L_sNe:
    s_lshl_b32 s71, s73, 18
    s_add_u32 s72, s71, 131072
    s_cmp_lt_u32 s47, 5
    s_cselect_b32 s58, 1051011932, 1.0
    ds_read_b64_tr_b16 v[64:65], v13 offset:32768
    ds_read_b64_tr_b16 v[66:67], v13 offset:33792
    ds_read_b64_tr_b16 v[68:69], v14 offset:32768
    ds_read_b64_tr_b16 v[70:71], v14 offset:33792
    ds_read_b64_tr_b16 v[72:73], v15 offset:32768
    ds_read_b64_tr_b16 v[74:75], v15 offset:33792
    ds_read_b64_tr_b16 v[76:77], v16 offset:32768
    ds_read_b64_tr_b16 v[78:79], v16 offset:33792
    v_mul_f32 v241, s58, v241
    v_mul_f32 v243, s58, v243
    v_mul_f32 v245, s58, v245
    v_mul_f32 v247, s58, v247
    v_pk_fma_f32 v[96:97], v[224:225], v[240:241], v[96:97] op_sel:[0,0,0] op_sel_hi:[1,0,1]
    v_pk_fma_f32 v[98:99], v[226:227], v[240:241], v[98:99] op_sel:[0,0,0] op_sel_hi:[1,0,1]
    v_pk_fma_f32 v[100:101], v[228:229], v[240:241], v[100:101] op_sel:[0,0,0] op_sel_hi:[1,0,1]
    v_pk_fma_f32 v[102:103], v[230:231], v[240:241], v[102:103] op_sel:[0,0,0] op_sel_hi:[1,0,1]
    v_pk_mul_f32 v[96:97], v[96:97], v[240:241] op_sel:[0,1] op_sel_hi:[1,1]
    v_pk_mul_f32 v[98:99], v[98:99], v[240:241] op_sel:[0,1] op_sel_hi:[1,1]
    v_pk_mul_f32 v[100:101], v[100:101], v[240:241] op_sel:[0,1] op_sel_hi:[1,1]
    v_pk_mul_f32 v[102:103], v[102:103], v[240:241] op_sel:[0,1] op_sel_hi:[1,1]
    v_cvt_pk_bf16_f32 v248, v96, v97
    v_cvt_pk_bf16_f32 v249, v98, v99
    v_cvt_pk_bf16_f32 v250, v100, v101
    v_cvt_pk_bf16_f32 v251, v102, v103
    v_pk_fma_f32 v[104:105], v[232:233], v[240:241], v[104:105] op_sel:[0,0,0] op_sel_hi:[1,0,1]
    v_pk_fma_f32 v[106:107], v[234:235], v[240:241], v[106:107] op_sel:[0,0,0] op_sel_hi:[1,0,1]
    v_pk_fma_f32 v[108:109], v[236:237], v[240:241], v[108:109] op_sel:[0,0,0] op_sel_hi:[1,0,1]
    v_pk_fma_f32 v[110:111], v[238:239], v[240:241], v[110:111] op_sel:[0,0,0] op_sel_hi:[1,0,1]
    v_pk_mul_f32 v[104:105], v[104:105], v[240:241] op_sel:[0,1] op_sel_hi:[1,1]
    v_pk_mul_f32 v[106:107], v[106:107], v[240:241] op_sel:[0,1] op_sel_hi:[1,1]
    v_pk_mul_f32 v[108:109], v[108:109], v[240:241] op_sel:[0,1] op_sel_hi:[1,1]
    v_pk_mul_f32 v[110:111], v[110:111], v[240:241] op_sel:[0,1] op_sel_hi:[1,1]
    v_permlane16_swap_b32 v248, v250
    v_permlane16_swap_b32 v249, v251
    buffer_store_dwordx4 v[248:251], v19, s[24:27], s71 offen offset:0 sc1
    v_cvt_pk_bf16_f32 v252, v104, v105
    v_cvt_pk_bf16_f32 v253, v106, v107
    v_cvt_pk_bf16_f32 v254, v108, v109
    v_cvt_pk_bf16_f32 v255, v110, v111
    v_pk_fma_f32 v[112:113], v[224:225], v[242:243], v[112:113] op_sel:[0,0,0] op_sel_hi:[1,0,1]
    v_pk_fma_f32 v[114:115], v[226:227], v[242:243], v[114:115] op_sel:[0,0,0] op_sel_hi:[1,0,1]
    v_pk_fma_f32 v[116:117], v[228:229], v[242:243], v[116:117] op_sel:[0,0,0] op_sel_hi:[1,0,1]
    v_pk_fma_f32 v[118:119], v[230:231], v[242:243], v[118:119] op_sel:[0,0,0] op_sel_hi:[1,0,1]
    v_pk_mul_f32 v[112:113], v[112:113], v[242:243] op_sel:[0,1] op_sel_hi:[1,1]
    v_pk_mul_f32 v[114:115], v[114:115], v[242:243] op_sel:[0,1] op_sel_hi:[1,1]
    v_pk_mul_f32 v[116:117], v[116:117], v[242:243] op_sel:[0,1] op_sel_hi:[1,1]
    v_pk_mul_f32 v[118:119], v[118:119], v[242:243] op_sel:[0,1] op_sel_hi:[1,1]
    v_permlane16_swap_b32 v252, v254
    v_permlane16_swap_b32 v253, v255
    buffer_store_dwordx4 v[252:255], v19, s[24:27], s72 offen offset:0 sc1
    v_cvt_pk_bf16_f32 v248, v112, v113
    v_cvt_pk_bf16_f32 v249, v114, v115
    v_cvt_pk_bf16_f32 v250, v116, v117
    v_cvt_pk_bf16_f32 v251, v118, v119
    v_pk_fma_f32 v[120:121], v[232:233], v[242:243], v[120:121] op_sel:[0,0,0] op_sel_hi:[1,0,1]
    v_pk_fma_f32 v[122:123], v[234:235], v[242:243], v[122:123] op_sel:[0,0,0] op_sel_hi:[1,0,1]
    v_pk_fma_f32 v[124:125], v[236:237], v[242:243], v[124:125] op_sel:[0,0,0] op_sel_hi:[1,0,1]
    v_pk_fma_f32 v[126:127], v[238:239], v[242:243], v[126:127] op_sel:[0,0,0] op_sel_hi:[1,0,1]
    v_pk_mul_f32 v[120:121], v[120:121], v[242:243] op_sel:[0,1] op_sel_hi:[1,1]
    v_pk_mul_f32 v[122:123], v[122:123], v[242:243] op_sel:[0,1] op_sel_hi:[1,1]
    v_pk_mul_f32 v[124:125], v[124:125], v[242:243] op_sel:[0,1] op_sel_hi:[1,1]
    v_pk_mul_f32 v[126:127], v[126:127], v[242:243] op_sel:[0,1] op_sel_hi:[1,1]
    v_permlane16_swap_b32 v248, v250
    v_permlane16_swap_b32 v249, v251
    buffer_store_dwordx4 v[248:251], v19, s[24:27], s71 offen offset:256 sc1
    v_cvt_pk_bf16_f32 v252, v120, v121
    v_cvt_pk_bf16_f32 v253, v122, v123
    v_cvt_pk_bf16_f32 v254, v124, v125
    v_cvt_pk_bf16_f32 v255, v126, v127
    v_pk_fma_f32 v[128:129], v[224:225], v[244:245], v[128:129] op_sel:[0,0,0] op_sel_hi:[1,0,1]
    v_pk_fma_f32 v[130:131], v[226:227], v[244:245], v[130:131] op_sel:[0,0,0] op_sel_hi:[1,0,1]
    v_pk_fma_f32 v[132:133], v[228:229], v[244:245], v[132:133] op_sel:[0,0,0] op_sel_hi:[1,0,1]
    v_pk_fma_f32 v[134:135], v[230:231], v[244:245], v[134:135] op_sel:[0,0,0] op_sel_hi:[1,0,1]
    v_pk_mul_f32 v[128:129], v[128:129], v[244:245] op_sel:[0,1] op_sel_hi:[1,1]
    v_pk_mul_f32 v[130:131], v[130:131], v[244:245] op_sel:[0,1] op_sel_hi:[1,1]
    v_pk_mul_f32 v[132:133], v[132:133], v[244:245] op_sel:[0,1] op_sel_hi:[1,1]
    v_pk_mul_f32 v[134:135], v[134:135], v[244:245] op_sel:[0,1] op_sel_hi:[1,1]
    v_permlane16_swap_b32 v252, v254
    v_permlane16_swap_b32 v253, v255
    buffer_store_dwordx4 v[252:255], v19, s[24:27], s72 offen offset:256 sc1
    v_cvt_pk_bf16_f32 v248, v128, v129
    v_cvt_pk_bf16_f32 v249, v130, v131
    v_cvt_pk_bf16_f32 v250, v132, v133
    v_cvt_pk_bf16_f32 v251, v134, v135
    v_pk_fma_f32 v[136:137], v[232:233], v[244:245], v[136:137] op_sel:[0,0,0] op_sel_hi:[1,0,1]
    v_pk_fma_f32 v[138:139], v[234:235], v[244:245], v[138:139] op_sel:[0,0,0] op_sel_hi:[1,0,1]
    v_pk_fma_f32 v[140:141], v[236:237], v[244:245], v[140:141] op_sel:[0,0,0] op_sel_hi:[1,0,1]
    v_pk_fma_f32 v[142:143], v[238:239], v[244:245], v[142:143] op_sel:[0,0,0] op_sel_hi:[1,0,1]
    v_pk_mul_f32 v[136:137], v[136:137], v[244:245] op_sel:[0,1] op_sel_hi:[1,1]
    v_pk_mul_f32 v[138:139], v[138:139], v[244:245] op_sel:[0,1] op_sel_hi:[1,1]
    v_pk_mul_f32 v[140:141], v[140:141], v[244:245] op_sel:[0,1] op_sel_hi:[1,1]
    v_pk_mul_f32 v[142:143], v[142:143], v[244:245] op_sel:[0,1] op_sel_hi:[1,1]
    v_permlane16_swap_b32 v248, v250
    v_permlane16_swap_b32 v249, v251
    buffer_store_dwordx4 v[248:251], v19, s[24:27], s71 offen offset:512 sc1
    v_cvt_pk_bf16_f32 v252, v136, v137
    v_cvt_pk_bf16_f32 v253, v138, v139
    v_cvt_pk_bf16_f32 v254, v140, v141
    v_cvt_pk_bf16_f32 v255, v142, v143
    v_pk_fma_f32 v[144:145], v[224:225], v[246:247], v[144:145] op_sel:[0,0,0] op_sel_hi:[1,0,1]
    v_pk_fma_f32 v[146:147], v[226:227], v[246:247], v[146:147] op_sel:[0,0,0] op_sel_hi:[1,0,1]
    v_pk_fma_f32 v[148:149], v[228:229], v[246:247], v[148:149] op_sel:[0,0,0] op_sel_hi:[1,0,1]
    v_pk_fma_f32 v[150:151], v[230:231], v[246:247], v[150:151] op_sel:[0,0,0] op_sel_hi:[1,0,1]
    v_pk_mul_f32 v[144:145], v[144:145], v[246:247] op_sel:[0,1] op_sel_hi:[1,1]
    v_pk_mul_f32 v[146:147], v[146:147], v[246:247] op_sel:[0,1] op_sel_hi:[1,1]
    v_pk_mul_f32 v[148:149], v[148:149], v[246:247] op_sel:[0,1] op_sel_hi:[1,1]
    v_pk_mul_f32 v[150:151], v[150:151], v[246:247] op_sel:[0,1] op_sel_hi:[1,1]
    v_permlane16_swap_b32 v252, v254
    v_permlane16_swap_b32 v253, v255
    buffer_store_dwordx4 v[252:255], v19, s[24:27], s72 offen offset:512 sc1
    v_cvt_pk_bf16_f32 v248, v144, v145
    v_cvt_pk_bf16_f32 v249, v146, v147
    v_cvt_pk_bf16_f32 v250, v148, v149
    v_cvt_pk_bf16_f32 v251, v150, v151
    v_pk_fma_f32 v[152:153], v[232:233], v[246:247], v[152:153] op_sel:[0,0,0] op_sel_hi:[1,0,1]
    v_pk_fma_f32 v[154:155], v[234:235], v[246:247], v[154:155] op_sel:[0,0,0] op_sel_hi:[1,0,1]
    v_pk_fma_f32 v[156:157], v[236:237], v[246:247], v[156:157] op_sel:[0,0,0] op_sel_hi:[1,0,1]
    v_pk_fma_f32 v[158:159], v[238:239], v[246:247], v[158:159] op_sel:[0,0,0] op_sel_hi:[1,0,1]
    v_pk_mul_f32 v[152:153], v[152:153], v[246:247] op_sel:[0,1] op_sel_hi:[1,1]
    v_pk_mul_f32 v[154:155], v[154:155], v[246:247] op_sel:[0,1] op_sel_hi:[1,1]
    v_pk_mul_f32 v[156:157], v[156:157], v[246:247] op_sel:[0,1] op_sel_hi:[1,1]
    v_pk_mul_f32 v[158:159], v[158:159], v[246:247] op_sel:[0,1] op_sel_hi:[1,1]
    v_permlane16_swap_b32 v248, v250
    v_permlane16_swap_b32 v249, v251
    buffer_store_dwordx4 v[248:251], v19, s[24:27], s71 offen offset:768 sc1
    v_cvt_pk_bf16_f32 v252, v152, v153
    v_cvt_pk_bf16_f32 v253, v154, v155
    v_cvt_pk_bf16_f32 v254, v156, v157
    v_cvt_pk_bf16_f32 v255, v158, v159
    s_nop 1
    v_permlane16_swap_b32 v252, v254
    v_permlane16_swap_b32 v253, v255
    buffer_store_dwordx4 v[252:255], v19, s[24:27], s72 offen offset:768 sc1
    s_cmp_ge_u32 s68, 27
    s_cbranch_scc1 L_a_only
L_a_done:
    s_waitcnt lgkmcnt(0)
    s_barrier
.p2align 3
L_sF:
    v_mfma_f32_16x16x32_bf16 v[160:163], v[64:67], v[32:35], v[160:163]
    ds_read_b64_tr_b16 v[80:81], v13 offset:40960
    v_mfma_f32_16x16x32_bf16 v[164:167], v[68:71], v[32:35], v[164:167]
    ds_read_b64_tr_b16 v[82:83], v13 offset:41984
    v_mfma_f32_16x16x32_bf16 v[168:171], v[72:75], v[32:35], v[168:171]
    ds_read_b128 v[48:51], v12 offset:0
    v_mfma_f32_16x16x32_bf16 v[172:175], v[76:79], v[32:35], v[172:175]
    ds_read_b64_tr_b16 v[84:85], v14 offset:40960
    v_mfma_f32_16x16x32_bf16 v[176:179], v[64:67], v[36:39], v[176:179]
    ds_read_b64_tr_b16 v[86:87], v14 offset:41984
    v_mfma_f32_16x16x32_bf16 v[180:183], v[68:71], v[36:39], v[180:183]
    ds_read_b64_tr_b16 v[88:89], v15 offset:40960
    v_mfma_f32_16x16x32_bf16 v[184:187], v[72:75], v[36:39], v[184:187]
    ds_read_b64_tr_b16 v[90:91], v15 offset:41984
    v_mfma_f32_16x16x32_bf16 v[188:191], v[76:79], v[36:39], v[188:191]
    ds_read_b64_tr_b16 v[92:93], v16 offset:40960
    v_mfma_f32_16x16x32_bf16 v[192:195], v[64:67], v[40:43], v[192:195]
    s_add_u32 s64, s64, 1
    ds_read_b64_tr_b16 v[94:95], v16 offset:41984
    v_mfma_f32_16x16x32_bf16 v[196:199], v[68:71], v[40:43], v[196:199]
    s_cmp_eq_u32 s64, 3
    ds_read_b128 v[52:55], v12 offset:2048
    v_mfma_f32_16x16x32_bf16 v[200:203], v[72:75], v[40:43], v[200:203]
    s_cselect_b32 s62, 4294868992, s65
    ds_read_b128 v[56:59], v12 offset:4096
    v_mfma_f32_16x16x32_bf16 v[204:207], v[76:79], v[40:43], v[204:207]
    s_cselect_b32 s64, 0, s64
    ds_read_b128 v[60:63], v12 offset:6144
    v_mfma_f32_16x16x32_bf16 v[208:211], v[64:67], v[44:47], v[208:211]
    v_add_u32 v11, s62, v11
    v_add_u32 v12, s62, v12
    v_mfma_f32_16x16x32_bf16 v[212:215], v[68:71], v[44:47], v[212:215]
    v_add_u32 v13, s62, v13
    v_add_u32 v14, s62, v14
    v_mfma_f32_16x16x32_bf16 v[216:219], v[72:75], v[44:47], v[216:219]
    v_add_u32 v15, s62, v15
    v_add_u32 v16, s62, v16
    v_mfma_f32_16x16x32_bf16 v[220:223], v[76:79], v[44:47], v[220:223]
    s_waitcnt lgkmcnt(0)
    v_mfma_f32_16x16x32_bf16 v[160:163], v[80:83], v[48:51], v[160:163]
    ds_read_b64_tr_b16 v[64:65], v13 offset:32768
    v_mfma_f32_16x16x32_bf16 v[164:167], v[84:87], v[48:51], v[164:167]
    ds_read_b64_tr_b16 v[66:67], v13 offset:33792
    v_mfma_f32_16x16x32_bf16 v[168:171], v[88:91], v[48:51], v[168:171]
    ds_read_b128 v[32:35], v11 offset:0
    v_mfma_f32_16x16x32_bf16 v[172:175], v[92:95], v[48:51], v[172:175]
    ds_read_b64_tr_b16 v[68:69], v14 offset:32768
    v_mfma_f32_16x16x32_bf16 v[176:179], v[80:83], v[52:55], v[176:179]
    ds_read_b64_tr_b16 v[70:71], v14 offset:33792
    v_mfma_f32_16x16x32_bf16 v[180:183], v[84:87], v[52:55], v[180:183]
    ds_read_b64_tr_b16 v[72:73], v15 offset:32768
    v_mfma_f32_16x16x32_bf16 v[184:187], v[88:91], v[52:55], v[184:187]
    ds_read_b64_tr_b16 v[74:75], v15 offset:33792
    v_mfma_f32_16x16x32_bf16 v[188:191], v[92:95], v[52:55], v[188:191]
    ds_read_b64_tr_b16 v[76:77], v16 offset:32768
    v_mfma_f32_16x16x32_bf16 v[192:195], v[80:83], v[56:59], v[192:195]
    ds_read_b64_tr_b16 v[78:79], v16 offset:33792
    v_mfma_f32_16x16x32_bf16 v[196:199], v[84:87], v[56:59], v[196:199]
    ds_read_b128 v[36:39], v11 offset:2048
    v_mfma_f32_16x16x32_bf16 v[200:203], v[88:91], v[56:59], v[200:203]
    ds_read_b128 v[40:43], v11 offset:4096
    v_mfma_f32_16x16x32_bf16 v[204:207], v[92:95], v[56:59], v[204:207]
    ds_read_b128 v[44:47], v11 offset:6144
    v_mfma_f32_16x16x32_bf16 v[208:211], v[80:83], v[60:63], v[208:211]
    v_mfma_f32_16x16x32_bf16 v[212:215], v[84:87], v[60:63], v[212:215]
    s_add_u32 s56, s56, 1
    v_mfma_f32_16x16x32_bf16 v[216:219], v[88:91], v[60:63], v[216:219]
    s_cmp_lt_u32 s56, 0
    v_mfma_f32_16x16x32_bf16 v[220:223], v[92:95], v[60:63], v[220:223]
    s_waitcnt lgkmcnt(0)
    s_cbranch_scc1 L_sF
    s_cmp_eq_u32 s56, 13
    s_cbranch_scc1 L_eF
    s_cmp_eq_u32 s56, 12
    s_cbranch_scc1 L_hF
    ds_read_b128 v[96:99], v8 offset:1536
    ds_read_b128 v[100:103], v8 offset:1600
    ds_read_b128 v[104:107], v8 offset:1664
    ds_read_b128 v[108:111], v8 offset:1728
    ds_read_b128 v[112:115], v8 offset:2048
    ds_read_b128 v[116:119], v8 offset:2112
    ds_read_b128 v[120:123], v8 offset:2176
    ds_read_b128 v[124:127], v8 offset:2240
    ds_read2_b32 v[128:129], v9 offset0:0 offset1:128
    ds_read2_b32 v[130:131], v9 offset0:16 offset1:144
    ds_read2_b32 v[132:133], v9 offset0:32 offset1:160
    ds_read2_b32 v[134:135], v9 offset0:48 offset1:176
    s_branch L_sF
L_hF:
    s_waitcnt vmcnt(0)
    s_lshl_b32 s58, s70, 7
    s_add_u32 s58, s58, 20744192
    v_lshlrev_b32 v6, 2, v1
    v_mov_b32 v5, s55
    s_mov_b32 exec_hi, 0
    buffer_store_dword v5, v6, s[24:27], s58 offen sc1
    s_mov_b64 exec, -1
    s_barrier
    s_branch L_sF
L_eF:
    v_pk_fma_f32 v[160:161], v[96:97], v[128:129], v[160:161] op_sel:[0,0,0] op_sel_hi:[1,0,1]
    v_pk_fma_f32 v[162:163], v[98:99], v[128:129], v[162:163] op_sel:[0,0,0] op_sel_hi:[1,0,1]
    v_pk_fma_f32 v[164:165], v[100:101], v[128:129], v[164:165] op_sel:[0,0,0] op_sel_hi:[1,0,1]
    v_pk_fma_f32 v[166:167], v[102:103], v[128:129], v[166:167] op_sel:[0,0,0] op_sel_hi:[1,0,1]
    v_pk_fma_f32 v[160:161], v[160:161], v[128:129], v[112:113] op_sel:[0,1,0] op_sel_hi:[1,1,1]
    v_pk_fma_f32 v[162:163], v[162:163], v[128:129], v[114:115] op_sel:[0,1,0] op_sel_hi:[1,1,1]
    v_pk_fma_f32 v[164:165], v[164:165], v[128:129], v[116:117] op_sel:[0,1,0] op_sel_hi:[1,1,1]
    v_pk_fma_f32 v[166:167], v[166:167], v[128:129], v[118:119] op_sel:[0,1,0] op_sel_hi:[1,1,1]
    v_max_f32 v160, 0, v160
    v_max_f32 v161, 0, v161
    v_max_f32 v162, 0, v162
    v_max_f32 v163, 0, v163
    v_max_f32 v164, 0, v164
    v_max_f32 v165, 0, v165
    v_max_f32 v166, 0, v166
    v_max_f32 v167, 0, v167
    v_pk_mul_f32 v[160:161], v[160:161], v[160:161]
    v_pk_mul_f32 v[162:163], v[162:163], v[162:163]
    v_pk_mul_f32 v[164:165], v[164:165], v[164:165]
    v_pk_mul_f32 v[166:167], v[166:167], v[166:167]
    v_cvt_pk_bf16_f32 v32, v160, v161
    v_cvt_pk_bf16_f32 v33, v162, v163
    v_cvt_pk_bf16_f32 v34, v164, v165
    v_cvt_pk_bf16_f32 v35, v166, v167
    v_pk_fma_f32 v[168:169], v[104:105], v[128:129], v[168:169] op_sel:[0,0,0] op_sel_hi:[1,0,1]
    v_pk_fma_f32 v[170:171], v[106:107], v[128:129], v[170:171] op_sel:[0,0,0] op_sel_hi:[1,0,1]
    v_pk_fma_f32 v[172:173], v[108:109], v[128:129], v[172:173] op_sel:[0,0,0] op_sel_hi:[1,0,1]
    v_pk_fma_f32 v[174:175], v[110:111], v[128:129], v[174:175] op_sel:[0,0,0] op_sel_hi:[1,0,1]
    v_pk_fma_f32 v[168:169], v[168:169], v[128:129], v[120:121] op_sel:[0,1,0] op_sel_hi:[1,1,1]
    v_pk_fma_f32 v[170:171], v[170:171], v[128:129], v[122:123] op_sel:[0,1,0] op_sel_hi:[1,1,1]
    v_pk_fma_f32 v[172:173], v[172:173], v[128:129], v[124:125] op_sel:[0,1,0] op_sel_hi:[1,1,1]
    v_pk_fma_f32 v[174:175], v[174:175], v[128:129], v[126:127] op_sel:[0,1,0] op_sel_hi:[1,1,1]
    v_max_f32 v168, 0, v168
    v_max_f32 v169, 0, v169
    v_max_f32 v170, 0, v170
    v_max_f32 v171, 0, v171
    v_max_f32 v172, 0, v172
    v_max_f32 v173, 0, v173
    v_max_f32 v174, 0, v174
    v_max_f32 v175, 0, v175
    v_pk_mul_f32 v[168:169], v[168:169], v[168:169]
    v_pk_mul_f32 v[170:171], v[170:171], v[170:171]
    v_pk_mul_f32 v[172:173], v[172:173], v[172:173]
    v_pk_mul_f32 v[174:175], v[174:175], v[174:175]
    v_permlane16_swap_b32 v32, v34
    v_permlane16_swap_b32 v33, v35
    v_cvt_pk_bf16_f32 v48, v168, v169
    v_cvt_pk_bf16_f32 v49, v170, v171
    v_cvt_pk_bf16_f32 v50, v172, v173
    v_cvt_pk_bf16_f32 v51, v174, v175
    v_pk_fma_f32 v[176:177], v[96:97], v[130:131], v[176:177] op_sel:[0,0,0] op_sel_hi:[1,0,1]
    v_pk_fma_f32 v[178:179], v[98:99], v[130:131], v[178:179] op_sel:[0,0,0] op_sel_hi:[1,0,1]
    v_pk_fma_f32 v[180:181], v[100:101], v[130:131], v[180:181] op_sel:[0,0,0] op_sel_hi:[1,0,1]
    v_pk_fma_f32 v[182:183], v[102:103], v[130:131], v[182:183] op_sel:[0,0,0] op_sel_hi:[1,0,1]
    v_pk_fma_f32 v[176:177], v[176:177], v[130:131], v[112:113] op_sel:[0,1,0] op_sel_hi:[1,1,1]
    v_pk_fma_f32 v[178:179], v[178:179], v[130:131], v[114:115] op_sel:[0,1,0] op_sel_hi:[1,1,1]
    v_pk_fma_f32 v[180:181], v[180:181], v[130:131], v[116:117] op_sel:[0,1,0] op_sel_hi:[1,1,1]
    v_pk_fma_f32 v[182:183], v[182:183], v[130:131], v[118:119] op_sel:[0,1,0] op_sel_hi:[1,1,1]
    v_max_f32 v176, 0, v176
    v_max_f32 v177, 0, v177
    v_max_f32 v178, 0, v178
    v_max_f32 v179, 0, v179
    v_max_f32 v180, 0, v180
    v_max_f32 v181, 0, v181
    v_max_f32 v182, 0, v182
    v_max_f32 v183, 0, v183
    v_pk_mul_f32 v[176:177], v[176:177], v[176:177]
    v_pk_mul_f32 v[178:179], v[178:179], v[178:179]
    v_pk_mul_f32 v[180:181], v[180:181], v[180:181]
    v_pk_mul_f32 v[182:183], v[182:183], v[182:183]
    v_permlane16_swap_b32 v48, v50
    v_permlane16_swap_b32 v49, v51
    v_cvt_pk_bf16_f32 v36, v176, v177
    v_cvt_pk_bf16_f32 v37, v178, v179
    v_cvt_pk_bf16_f32 v38, v180, v181
    v_cvt_pk_bf16_f32 v39, v182, v183
    v_pk_fma_f32 v[184:185], v[104:105], v[130:131], v[184:185] op_sel:[0,0,0] op_sel_hi:[1,0,1]
    v_pk_fma_f32 v[186:187], v[106:107], v[130:131], v[186:187] op_sel:[0,0,0] op_sel_hi:[1,0,1]
    v_pk_fma_f32 v[188:189], v[108:109], v[130:131], v[188:189] op_sel:[0,0,0] op_sel_hi:[1,0,1]
    v_pk_fma_f32 v[190:191], v[110:111], v[130:131], v[190:191] op_sel:[0,0,0] op_sel_hi:[1,0,1]
    v_pk_fma_f32 v[184:185], v[184:185], v[130:131], v[120:121] op_sel:[0,1,0] op_sel_hi:[1,1,1]
    v_pk_fma_f32 v[186:187], v[186:187], v[130:131], v[122:123] op_sel:[0,1,0] op_sel_hi:[1,1,1]
    v_pk_fma_f32 v[188:189], v[188:189], v[130:131], v[124:125] op_sel:[0,1,0] op_sel_hi:[1,1,1]
    v_pk_fma_f32 v[190:191], v[190:191], v[130:131], v[126:127] op_sel:[0,1,0] op_sel_hi:[1,1,1]
    v_max_f32 v184, 0, v184
    v_max_f32 v185, 0, v185
    v_max_f32 v186, 0, v186
    v_max_f32 v187, 0, v187
    v_max_f32 v188, 0, v188
    v_max_f32 v189, 0, v189
    v_max_f32 v190, 0, v190
    v_max_f32 v191, 0, v191
    v_pk_mul_f32 v[184:185], v[184:185], v[184:185]
    v_pk_mul_f32 v[186:187], v[186:187], v[186:187]
    v_pk_mul_f32 v[188:189], v[188:189], v[188:189]
    v_pk_mul_f32 v[190:191], v[190:191], v[190:191]
    v_permlane16_swap_b32 v36, v38
    v_permlane16_swap_b32 v37, v39
    v_cvt_pk_bf16_f32 v52, v184, v185
    v_cvt_pk_bf16_f32 v53, v186, v187
    v_cvt_pk_bf16_f32 v54, v188, v189
    v_cvt_pk_bf16_f32 v55, v190, v191
    v_pk_fma_f32 v[192:193], v[96:97], v[132:133], v[192:193] op_sel:[0,0,0] op_sel_hi:[1,0,1]
    v_pk_fma_f32 v[194:195], v[98:99], v[132:133], v[194:195] op_sel:[0,0,0] op_sel_hi:[1,0,1]
    v_pk_fma_f32 v[196:197], v[100:101], v[132:133], v[196:197] op_sel:[0,0,0] op_sel_hi:[1,0,1]
    v_pk_fma_f32 v[198:199], v[102:103], v[132:133], v[198:199] op_sel:[0,0,0] op_sel_hi:[1,0,1]
    v_pk_fma_f32 v[192:193], v[192:193], v[132:133], v[112:113] op_sel:[0,1,0] op_sel_hi:[1,1,1]
    v_pk_fma_f32 v[194:195], v[194:195], v[132:133], v[114:115] op_sel:[0,1,0] op_sel_hi:[1,1,1]
    v_pk_fma_f32 v[196:197], v[196:197], v[132:133], v[116:117] op_sel:[0,1,0] op_sel_hi:[1,1,1]
    v_pk_fma_f32 v[198:199], v[198:199], v[132:133], v[118:119] op_sel:[0,1,0] op_sel_hi:[1,1,1]
    v_max_f32 v192, 0, v192
    v_max_f32 v193, 0, v193
    v_max_f32 v194, 0, v194
    v_max_f32 v195, 0, v195
    v_max_f32 v196, 0, v196
    v_max_f32 v197, 0, v197
    v_max_f32 v198, 0, v198
    v_max_f32 v199, 0, v199
    v_pk_mul_f32 v[192:193], v[192:193], v[192:193]
    v_pk_mul_f32 v[194:195], v[194:195], v[194:195]
    v_pk_mul_f32 v[196:197], v[196:197], v[196:197]
    v_pk_mul_f32 v[198:199], v[198:199], v[198:199]
    v_permlane16_swap_b32 v52, v54
    v_permlane16_swap_b32 v53, v55
    v_cvt_pk_bf16_f32 v40, v192, v193
    v_cvt_pk_bf16_f32 v41, v194, v195
    v_cvt_pk_bf16_f32 v42, v196, v197
    v_cvt_pk_bf16_f32 v43, v198, v199
    v_pk_fma_f32 v[200:201], v[104:105], v[132:133], v[200:201] op_sel:[0,0,0] op_sel_hi:[1,0,1]
    v_pk_fma_f32 v[202:203], v[106:107], v[132:133], v[202:203] op_sel:[0,0,0] op_sel_hi:[1,0,1]
    v_pk_fma_f32 v[204:205], v[108:109], v[132:133], v[204:205] op_sel:[0,0,0] op_sel_hi:[1,0,1]
    v_pk_fma_f32 v[206:207], v[110:111], v[132:133], v[206:207] op_sel:[0,0,0] op_sel_hi:[1,0,1]
    v_pk_fma_f32 v[200:201], v[200:201], v[132:133], v[120:121] op_sel:[0,1,0] op_sel_hi:[1,1,1]
    v_pk_fma_f32 v[202:203], v[202:203], v[132:133], v[122:123] op_sel:[0,1,0] op_sel_hi:[1,1,1]
    v_pk_fma_f32 v[204:205], v[204:205], v[132:133], v[124:125] op_sel:[0,1,0] op_sel_hi:[1,1,1]
    v_pk_fma_f32 v[206:207], v[206:207], v[132:133], v[126:127] op_sel:[0,1,0] op_sel_hi:[1,1,1]
    v_max_f32 v200, 0, v200
    v_max_f32 v201, 0, v201
    v_max_f32 v202, 0, v202
    v_max_f32 v203, 0, v203
    v_max_f32 v204, 0, v204
    v_max_f32 v205, 0, v205
    v_max_f32 v206, 0, v206
    v_max_f32 v207, 0, v207
    v_pk_mul_f32 v[200:201], v[200:201], v[200:201]
    v_pk_mul_f32 v[202:203], v[202:203], v[202:203]
    v_pk_mul_f32 v[204:205], v[204:205], v[204:205]
    v_pk_mul_f32 v[206:207], v[206:207], v[206:207]
    v_permlane16_swap_b32 v40, v42
    v_permlane16_swap_b32 v41, v43
    v_cvt_pk_bf16_f32 v56, v200, v201
    v_cvt_pk_bf16_f32 v57, v202, v203
    v_cvt_pk_bf16_f32 v58, v204, v205
    v_cvt_pk_bf16_f32 v59, v206, v207
    v_pk_fma_f32 v[208:209], v[96:97], v[134:135], v[208:209] op_sel:[0,0,0] op_sel_hi:[1,0,1]
    v_pk_fma_f32 v[210:211], v[98:99], v[134:135], v[210:211] op_sel:[0,0,0] op_sel_hi:[1,0,1]
    v_pk_fma_f32 v[212:213], v[100:101], v[134:135], v[212:213] op_sel:[0,0,0] op_sel_hi:[1,0,1]
    v_pk_fma_f32 v[214:215], v[102:103], v[134:135], v[214:215] op_sel:[0,0,0] op_sel_hi:[1,0,1]
    v_pk_fma_f32 v[208:209], v[208:209], v[134:135], v[112:113] op_sel:[0,1,0] op_sel_hi:[1,1,1]
    v_pk_fma_f32 v[210:211], v[210:211], v[134:135], v[114:115] op_sel:[0,1,0] op_sel_hi:[1,1,1]
    v_pk_fma_f32 v[212:213], v[212:213], v[134:135], v[116:117] op_sel:[0,1,0] op_sel_hi:[1,1,1]
    v_pk_fma_f32 v[214:215], v[214:215], v[134:135], v[118:119] op_sel:[0,1,0] op_sel_hi:[1,1,1]
    v_max_f32 v208, 0, v208
    v_max_f32 v209, 0, v209
    v_max_f32 v210, 0, v210
    v_max_f32 v211, 0, v211
    v_max_f32 v212, 0, v212
    v_max_f32 v213, 0, v213
    v_max_f32 v214, 0, v214
    v_max_f32 v215, 0, v215
    v_pk_mul_f32 v[208:209], v[208:209], v[208:209]
    v_pk_mul_f32 v[210:211], v[210:211], v[210:211]
    v_pk_mul_f32 v[212:213], v[212:213], v[212:213]
    v_pk_mul_f32 v[214:215], v[214:215], v[214:215]
    v_permlane16_swap_b32 v56, v58
    v_permlane16_swap_b32 v57, v59
    v_cvt_pk_bf16_f32 v44, v208, v209
    v_cvt_pk_bf16_f32 v45, v210, v211
    v_cvt_pk_bf16_f32 v46, v212, v213
    v_cvt_pk_bf16_f32 v47, v214, v215
    v_pk_fma_f32 v[216:217], v[104:105], v[134:135], v[216:217] op_sel:[0,0,0] op_sel_hi:[1,0,1]
    v_pk_fma_f32 v[218:219], v[106:107], v[134:135], v[218:219] op_sel:[0,0,0] op_sel_hi:[1,0,1]
    v_pk_fma_f32 v[220:221], v[108:109], v[134:135], v[220:221] op_sel:[0,0,0] op_sel_hi:[1,0,1]
    v_pk_fma_f32 v[222:223], v[110:111], v[134:135], v[222:223] op_sel:[0,0,0] op_sel_hi:[1,0,1]
    v_pk_fma_f32 v[216:217], v[216:217], v[134:135], v[120:121] op_sel:[0,1,0] op_sel_hi:[1,1,1]
    v_pk_fma_f32 v[218:219], v[218:219], v[134:135], v[122:123] op_sel:[0,1,0] op_sel_hi:[1,1,1]
    v_pk_fma_f32 v[220:221], v[220:221], v[134:135], v[124:125] op_sel:[0,1,0] op_sel_hi:[1,1,1]
    v_pk_fma_f32 v[222:223], v[222:223], v[134:135], v[126:127] op_sel:[0,1,0] op_sel_hi:[1,1,1]
    v_max_f32 v216, 0, v216
    v_max_f32 v217, 0, v217
    v_max_f32 v218, 0, v218
    v_max_f32 v219, 0, v219
    v_max_f32 v220, 0, v220
    v_max_f32 v221, 0, v221
    v_max_f32 v222, 0, v222
    v_max_f32 v223, 0, v223
    v_pk_mul_f32 v[216:217], v[216:217], v[216:217]
    v_pk_mul_f32 v[218:219], v[218:219], v[218:219]
    v_pk_mul_f32 v[220:221], v[220:221], v[220:221]
    v_pk_mul_f32 v[222:223], v[222:223], v[222:223]
    v_permlane16_swap_b32 v44, v46
    v_permlane16_swap_b32 v45, v47
    v_cvt_pk_bf16_f32 v60, v216, v217
    v_cvt_pk_bf16_f32 v61, v218, v219
    v_cvt_pk_bf16_f32 v62, v220, v221
    v_cvt_pk_bf16_f32 v63, v222, v223
    s_nop 1
    v_permlane16_swap_b32 v60, v62
    v_permlane16_swap_b32 v61, v63
    s_add_u32 s71, s68, 20
    s_lshl_b32 s71, s71, 18
    s_add_u32 s72, s71, 131072
L_a_go:
    s_and_b32 s70, s70, 31
    s_lshl_b32 s58, s68, 5
    s_add_u32 s70, s70, s58
    s_setprio 1
    s_mov_b32 s56, 0
    v_mov_b64 v[160:161], 0
    v_mov_b64 v[162:163], 0
    v_mov_b64 v[164:165], 0
    v_mov_b64 v[166:167], 0
    v_mov_b64 v[168:169], 0
    v_mov_b64 v[170:171], 0
    v_mov_b64 v[172:173], 0
    v_mov_b64 v[174:175], 0
    v_mov_b64 v[176:177], 0
    v_mov_b64 v[178:179], 0
    v_mov_b64 v[180:181], 0
    v_mov_b64 v[182:183], 0
    v_mov_b64 v[184:185], 0
    v_mov_b64 v[186:187], 0
    v_mov_b64 v[188:189], 0
    v_mov_b64 v[190:191], 0
    v_mov_b64 v[192:193], 0
    v_mov_b64 v[194:195], 0
    v_mov_b64 v[196:197], 0
    v_mov_b64 v[198:199], 0
    v_mov_b64 v[200:201], 0
    v_mov_b64 v[202:203], 0
    v_mov_b64 v[204:205], 0
    v_mov_b64 v[206:207], 0
    v_mov_b64 v[208:209], 0
    v_mov_b64 v[210:211], 0
    v_mov_b64 v[212:213], 0
    v_mov_b64 v[214:215], 0
    s_barrier
    buffer_store_dwordx4 v[32:35], v10, s[24:27], s71 offen offset:0 sc1
    buffer_store_dwordx4 v[36:39], v10, s[24:27], s71 offen offset:256 sc1
    buffer_store_dwordx4 v[40:43], v10, s[24:27], s71 offen offset:512 sc1
    buffer_store_dwordx4 v[44:47], v10, s[24:27], s71 offen offset:768 sc1
    buffer_store_dwordx4 v[48:51], v10, s[24:27], s72 offen offset:0 sc1
    buffer_store_dwordx4 v[52:55], v10, s[24:27], s72 offen offset:256 sc1
    buffer_store_dwordx4 v[56:59], v10, s[24:27], s72 offen offset:512 sc1
    buffer_store_dwordx4 v[60:63], v10, s[24:27], s72 offen offset:768 sc1
    s_barrier
    ds_read_b128 v[218:221], v26 offset:16384
    ds_read_b64 v[226:227], v30 offset:18432
    ds_read_b64 v[228:229], v31 offset:18432
    ds_read_b128 v[222:225], v26 offset:17408
    ds_read_b64 v[230:231], v30 offset:18944
    ds_read_b64 v[232:233], v31 offset:18944
    ds_read_b128 v[234:237], v27 offset:0
    ds_read_b64 v[242:243], v28 offset:8192
    ds_read_b128 v[238:241], v27 offset:1024
    ds_read_b128 v[246:249], v29 offset:12288
    ds_read_b128 v[208:211], v29 offset:12944
    s_waitcnt lgkmcnt(2)
    v_mfma_f32_32x32x16_bf16 v[96:111], v[234:237], v[218:221], 0
    v_mfma_f32_32x32x8_bf16 v[96:111], v[242:243], v[226:227], v[96:111]
    v_mfma_f32_32x32x16_bf16 v[112:127], v[238:241], v[218:221], 0
    v_mfma_f32_32x32x8_bf16 v[112:127], v[242:243], v[228:229], v[112:127]
    v_mfma_f32_32x32x16_bf16 v[144:159], v[234:237], v[222:225], 0
    s_nop 7
    s_nop 0
    v_mfma_f32_32x32x8_bf16 v[144:159], v[242:243], v[230:231], v[144:159]
    v_max3_f32 v216, v96, v97, v98
    v_max3_f32 v216, v216, v99, v100
    v_max3_f32 v216, v216, v101, v102
    v_max3_f32 v216, v216, v103, v104
    v_max3_f32 v216, v216, v105, v106
    v_max3_f32 v216, v216, v107, v108
    v_mfma_f32_32x32x16_bf16 v[128:143], v[238:241], v[222:225], 0
    v_max3_f32 v216, v216, v109, v110
    v_max3_f32 v216, v216, v111, v112
    v_max3_f32 v216, v216, v113, v114
    v_max3_f32 v216, v216, v115, v116
    v_max3_f32 v216, v216, v117, v118
    v_max3_f32 v216, v216, v119, v120
    v_mfma_f32_32x32x8_bf16 v[128:143], v[242:243], v[232:233], v[128:143]
    v_max3_f32 v216, v216, v121, v122
    v_max3_f32 v216, v216, v123, v124
    v_max3_f32 v216, v216, v125, v126
    v_max_f32 v216, v216, v127
    v_mov_b32 v4, v216
    s_nop 1
    v_permlane32_swap_b32 v216, v4
    v_max_f32 v216, v216, v4
    v_sub_f32 v112, 3266838528, v216
    v_mov_b32 v113, v112
    v_mov_b64 v[114:115], v[112:113]
    v_mov_b64 v[116:117], v[112:113]
    v_mov_b64 v[118:119], v[112:113]
    v_mov_b64 v[120:121], v[112:113]
    v_mov_b64 v[122:123], v[112:113]
    v_mov_b64 v[124:125], v[112:113]
    v_mov_b64 v[126:127], v[112:113]
    s_nop 1
    v_mfma_f32_32x32x16_bf16 v[96:111], v[234:237], v[218:221], v[112:127]
    v_max3_f32 v217, v144, v145, v146
    v_max3_f32 v217, v217, v147, v148
    v_max3_f32 v217, v217, v149, v150
    v_max3_f32 v217, v217, v151, v152
    v_max3_f32 v217, v217, v153, v154
    v_max3_f32 v217, v217, v155, v156
    v_max3_f32 v217, v217, v157, v158
    v_mfma_f32_32x32x8_bf16 v[96:111], v[242:243], v[226:227], v[96:111]
    v_max3_f32 v217, v217, v159, v128
    v_max3_f32 v217, v217, v129, v130
    v_max3_f32 v217, v217, v131, v132
    v_max3_f32 v217, v217, v133, v134
    v_max3_f32 v217, v217, v135, v136
    v_max3_f32 v217, v217, v137, v138
    v_max3_f32 v217, v217, v139, v140
    v_max3_f32 v217, v217, v141, v142
    v_max_f32 v217, v217, v143
    v_mov_b32 v4, v217
    s_nop 1
    v_permlane32_swap_b32 v217, v4
    v_max_f32 v217, v217, v4
    v_sub_f32 v128, 3266838528, v217
    v_mov_b32 v129, v128
    v_mov_b64 v[130:131], v[128:129]
    v_mov_b64 v[132:133], v[128:129]
    v_mov_b64 v[134:135], v[128:129]
    v_mov_b64 v[136:137], v[128:129]
    v_mov_b64 v[138:139], v[128:129]
    v_mov_b64 v[140:141], v[128:129]
    v_mov_b64 v[142:143], v[128:129]
    s_waitcnt lgkmcnt(0)
    s_branch L_aent
.p2align 3
L_aloop:
    v_exp_f32 v174, v174
    v_exp_f32 v175, v175
L_aent:
    v_exp_f32 v96, v96
    v_exp_f32 v97, v97
    v_smfmac_f32_32x32x32_bf16 v[192:207], v[212:215], v[168:175], v20
    ds_read_b128 v[212:215], v29 offset:14256
    v_exp_f32 v98, v98
    v_exp_f32 v99, v99
    v_exp_f32 v100, v100
    v_mfma_f32_32x32x16_bf16 v[160:175], v[234:237], v[222:225], v[128:143]
    s_waitcnt lgkmcnt(1)
    ds_read_b128 v[234:237], v27 offset:2048
    v_exp_f32 v101, v101
    v_exp_f32 v102, v102
    v_exp_f32 v103, v103
    v_mfma_f32_32x32x8_bf16 v[160:175], v[242:243], v[230:231], v[160:175]
    v_exp_f32 v104, v104
    v_exp_f32 v105, v105
    v_exp_f32 v106, v106
    v_exp_f32 v107, v107
    v_exp_f32 v108, v108
    v_exp_f32 v109, v109
    v_smfmac_f32_32x32x32_bf16 v[176:191], v[246:249], v[96:103], v20
    v_exp_f32 v110, v110
    v_exp_f32 v111, v111
    v_exp_f32 v160, v160
    v_exp_f32 v161, v161
    v_smfmac_f32_32x32x32_bf16 v[176:191], v[208:211], v[104:111], v20
    v_exp_f32 v162, v162
    v_exp_f32 v163, v163
    v_exp_f32 v164, v164
    v_mfma_f32_32x32x16_bf16 v[96:111], v[238:241], v[218:221], v[112:127]
    ds_read_b128 v[250:253], v29 offset:13600
    v_exp_f32 v165, v165
    v_exp_f32 v166, v166
    v_exp_f32 v167, v167
    v_mfma_f32_32x32x8_bf16 v[96:111], v[242:243], v[228:229], v[96:111]
    v_exp_f32 v168, v168
    v_exp_f32 v169, v169
    v_exp_f32 v170, v170
    v_exp_f32 v171, v171
    v_exp_f32 v172, v172
    v_exp_f32 v173, v173
    v_smfmac_f32_32x32x32_bf16 v[192:207], v[246:249], v[160:167], v20
    ds_read_b64 v[244:245], v28 offset:9216
    v_exp_f32 v174, v174
    v_exp_f32 v175, v175
    v_exp_f32 v96, v96
    v_exp_f32 v97, v97
    v_smfmac_f32_32x32x32_bf16 v[192:207], v[208:211], v[168:175], v20
    ds_read_b128 v[208:211], v29 offset:15568
    v_exp_f32 v98, v98
    v_exp_f32 v99, v99
    v_exp_f32 v100, v100
    v_mfma_f32_32x32x16_bf16 v[160:175], v[238:241], v[222:225], v[128:143]
    s_waitcnt lgkmcnt(2)
    ds_read_b128 v[238:241], v27 offset:3072
    v_exp_f32 v101, v101
    v_exp_f32 v102, v102
    v_exp_f32 v103, v103
    v_mfma_f32_32x32x8_bf16 v[160:175], v[242:243], v[232:233], v[160:175]
    v_exp_f32 v104, v104
    v_exp_f32 v105, v105
    v_exp_f32 v106, v106
    v_exp_f32 v107, v107
    v_exp_f32 v108, v108
    v_exp_f32 v109, v109
    v_smfmac_f32_32x32x32_bf16 v[176:191], v[250:253], v[96:103], v20
    v_exp_f32 v110, v110
    v_exp_f32 v111, v111
    v_exp_f32 v160, v160
    v_exp_f32 v161, v161
    v_smfmac_f32_32x32x32_bf16 v[176:191], v[212:215], v[104:111], v20
    v_exp_f32 v162, v162
    v_exp_f32 v163, v163
    v_exp_f32 v164, v164
    v_mfma_f32_32x32x16_bf16 v[96:111], v[234:237], v[218:221], v[112:127]
    s_waitcnt lgkmcnt(2)
    ds_read_b128 v[246:249], v29 offset:14912
    v_exp_f32 v165, v165
    v_exp_f32 v166, v166
    v_exp_f32 v167, v167
    v_mfma_f32_32x32x8_bf16 v[96:111], v[244:245], v[226:227], v[96:111]
    v_exp_f32 v168, v168
    v_exp_f32 v169, v169
    v_exp_f32 v170, v170
    v_exp_f32 v171, v171
    v_exp_f32 v172, v172
    v_exp_f32 v173, v173
    v_smfmac_f32_32x32x32_bf16 v[192:207], v[250:253], v[160:167], v20
    v_exp_f32 v174, v174
    v_exp_f32 v175, v175
    v_exp_f32 v96, v96
    v_exp_f32 v97, v97
    v_smfmac_f32_32x32x32_bf16 v[192:207], v[212:215], v[168:175], v20
    ds_read_b128 v[212:215], v29 offset:16880
    v_exp_f32 v98, v98
    v_exp_f32 v99, v99
    v_exp_f32 v100, v100
    v_mfma_f32_32x32x16_bf16 v[160:175], v[234:237], v[222:225], v[128:143]
    s_waitcnt lgkmcnt(1)
    ds_read_b128 v[234:237], v27 offset:4096
    v_exp_f32 v101, v101
    v_exp_f32 v102, v102
    v_exp_f32 v103, v103
    v_mfma_f32_32x32x8_bf16 v[160:175], v[244:245], v[230:231], v[160:175]
    v_exp_f32 v104, v104
    v_exp_f32 v105, v105
    v_exp_f32 v106, v106
    v_exp_f32 v107, v107
    v_exp_f32 v108, v108
    v_exp_f32 v109, v109
    v_smfmac_f32_32x32x32_bf16 v[176:191], v[246:249], v[96:103], v20
    v_exp_f32 v110, v110
    v_exp_f32 v111, v111
    v_exp_f32 v160, v160
    v_exp_f32 v161, v161
    v_smfmac_f32_32x32x32_bf16 v[176:191], v[208:211], v[104:111], v20
    v_exp_f32 v162, v162
    v_exp_f32 v163, v163
    v_exp_f32 v164, v164
    v_mfma_f32_32x32x16_bf16 v[96:111], v[238:241], v[218:221], v[112:127]
    ds_read_b128 v[250:253], v29 offset:16224
    v_exp_f32 v165, v165
    v_exp_f32 v166, v166
    v_exp_f32 v167, v167
    v_mfma_f32_32x32x8_bf16 v[96:111], v[244:245], v[228:229], v[96:111]
    v_exp_f32 v168, v168
    v_exp_f32 v169, v169
    v_exp_f32 v170, v170
    v_exp_f32 v171, v171
    v_exp_f32 v172, v172
    v_exp_f32 v173, v173
    v_smfmac_f32_32x32x32_bf16 v[192:207], v[246:249], v[160:167], v20
    ds_read_b64 v[242:243], v28 offset:10240
    v_exp_f32 v174, v174
    v_exp_f32 v175, v175
    v_exp_f32 v96, v96
    v_exp_f32 v97, v97
    v_smfmac_f32_32x32x32_bf16 v[192:207], v[208:211], v[168:175], v20
    ds_read_b128 v[208:211], v29 offset:18192
    v_exp_f32 v98, v98
    v_exp_f32 v99, v99
    v_exp_f32 v100, v100
    v_mfma_f32_32x32x16_bf16 v[160:175], v[238:241], v[222:225], v[128:143]
    s_waitcnt lgkmcnt(2)
    ds_read_b128 v[238:241], v27 offset:5120
    v_exp_f32 v101, v101
    v_exp_f32 v102, v102
    v_exp_f32 v103, v103
    v_mfma_f32_32x32x8_bf16 v[160:175], v[244:245], v[232:233], v[160:175]
    v_exp_f32 v104, v104
    v_exp_f32 v105, v105
    v_exp_f32 v106, v106
    v_exp_f32 v107, v107
    v_exp_f32 v108, v108
    v_exp_f32 v109, v109
    v_smfmac_f32_32x32x32_bf16 v[176:191], v[250:253], v[96:103], v20
    v_exp_f32 v110, v110
    v_exp_f32 v111, v111
    v_exp_f32 v160, v160
    v_exp_f32 v161, v161
    v_smfmac_f32_32x32x32_bf16 v[176:191], v[212:215], v[104:111], v20
    s_cmp_eq_u32 s56, 0
    v_exp_f32 v162, v162
    v_exp_f32 v163, v163
    v_exp_f32 v164, v164
    v_mfma_f32_32x32x16_bf16 v[96:111], v[234:237], v[218:221], v[112:127]
    s_waitcnt lgkmcnt(2)
    ds_read_b128 v[246:249], v29 offset:17536
    v_exp_f32 v165, v165
    v_exp_f32 v166, v166
    v_exp_f32 v167, v167
    v_mfma_f32_32x32x8_bf16 v[96:111], v[242:243], v[226:227], v[96:111]
    v_exp_f32 v168, v168
    v_exp_f32 v169, v169
    v_exp_f32 v170, v170
    v_exp_f32 v171, v171
    v_exp_f32 v172, v172
    v_exp_f32 v173, v173
    v_smfmac_f32_32x32x32_bf16 v[192:207], v[250:253], v[160:167], v20
    s_cbranch_scc1 L_hk
L_hk_r:
    v_exp_f32 v174, v174
    v_exp_f32 v175, v175
    v_exp_f32 v96, v96
    v_exp_f32 v97, v97
    v_smfmac_f32_32x32x32_bf16 v[192:207], v[212:215], v[168:175], v20
    s_add_u32 s57, s57, 22784
    ds_read_b128 v[212:215], v29 offset:19504
    v_exp_f32 v98, v98
    v_exp_f32 v99, v99
    v_exp_f32 v100, v100
    v_mfma_f32_32x32x16_bf16 v[160:175], v[234:237], v[222:225], v[128:143]
    s_waitcnt lgkmcnt(1)
    ds_read_b128 v[234:237], v27 offset:6144
    v_exp_f32 v101, v101
    v_exp_f32 v102, v102
    v_exp_f32 v103, v103
    v_mfma_f32_32x32x8_bf16 v[160:175], v[242:243], v[230:231], v[160:175]
    v_exp_f32 v104, v104
    v_exp_f32 v105, v105
    v_exp_f32 v106, v106
    v_exp_f32 v107, v107
    v_exp_f32 v108, v108
    v_exp_f32 v109, v109
    v_smfmac_f32_32x32x32_bf16 v[176:191], v[246:249], v[96:103], v20
    v_exp_f32 v110, v110
    v_exp_f32 v111, v111
    v_exp_f32 v160, v160
    v_exp_f32 v161, v161
    v_smfmac_f32_32x32x32_bf16 v[176:191], v[208:211], v[104:111], v20
    s_cmp_eq_u32 s57, 68352
    v_exp_f32 v162, v162
    v_exp_f32 v163, v163
    v_exp_f32 v164, v164
    v_mfma_f32_32x32x16_bf16 v[96:111], v[238:241], v[218:221], v[112:127]
    ds_read_b128 v[250:253], v29 offset:18848
    v_exp_f32 v165, v165
    v_exp_f32 v166, v166
    v_exp_f32 v167, v167
    v_mfma_f32_32x32x8_bf16 v[96:111], v[242:243], v[228:229], v[96:111]
    v_exp_f32 v168, v168
    v_exp_f32 v169, v169
    v_exp_f32 v170, v170
    v_exp_f32 v171, v171
    v_exp_f32 v172, v172
    v_exp_f32 v173, v173
    v_smfmac_f32_32x32x32_bf16 v[192:207], v[246:249], v[160:167], v20
    s_cselect_b32 s57, 0, s57
    ds_read_b64 v[244:245], v28 offset:11264
    v_exp_f32 v174, v174
    v_exp_f32 v175, v175
    v_exp_f32 v96, v96
    v_exp_f32 v97, v97
    v_smfmac_f32_32x32x32_bf16 v[192:207], v[208:211], v[168:175], v20
    ds_read_b128 v[208:211], v29 offset:20816
    v_exp_f32 v98, v98
    v_exp_f32 v99, v99
    v_exp_f32 v100, v100
    v_mfma_f32_32x32x16_bf16 v[160:175], v[238:241], v[222:225], v[128:143]
    s_waitcnt lgkmcnt(2)
    ds_read_b128 v[238:241], v27 offset:7168
    v_exp_f32 v101, v101
    v_exp_f32 v102, v102
    v_exp_f32 v103, v103
    v_mfma_f32_32x32x8_bf16 v[160:175], v[242:243], v[232:233], v[160:175]
    v_exp_f32 v104, v104
    v_exp_f32 v105, v105
    v_exp_f32 v106, v106
    v_exp_f32 v107, v107
    v_exp_f32 v108, v108
    v_exp_f32 v109, v109
    v_smfmac_f32_32x32x32_bf16 v[176:191], v[250:253], v[96:103], v20
    v_exp_f32 v110, v110
    v_exp_f32 v111, v111
    v_exp_f32 v160, v160
    v_exp_f32 v161, v161
    v_smfmac_f32_32x32x32_bf16 v[176:191], v[212:215], v[104:111], v20
    v_exp_f32 v162, v162
    v_exp_f32 v163, v163
    v_exp_f32 v164, v164
    v_mfma_f32_32x32x16_bf16 v[96:111], v[234:237], v[218:221], v[112:127]
    s_waitcnt lgkmcnt(2)
    ds_read_b128 v[246:249], v29 offset:20160
    v_exp_f32 v165, v165
    v_exp_f32 v166, v166
    v_exp_f32 v167, v167
    v_mfma_f32_32x32x8_bf16 v[96:111], v[244:245], v[226:227], v[96:111]
    v_exp_f32 v168, v168
    v_exp_f32 v169, v169
    v_exp_f32 v170, v170
    v_exp_f32 v171, v171
    v_exp_f32 v172, v172
    v_exp_f32 v173, v173
    v_smfmac_f32_32x32x32_bf16 v[192:207], v[250:253], v[160:167], v20
    v_exp_f32 v174, v174
    v_exp_f32 v175, v175
    v_exp_f32 v96, v96
    v_exp_f32 v97, v97
    v_smfmac_f32_32x32x32_bf16 v[192:207], v[212:215], v[168:175], v20
    s_barrier
    ds_read_b128 v[212:215], v29 offset:22128
    v_exp_f32 v98, v98
    v_exp_f32 v99, v99
    v_exp_f32 v100, v100
    v_add_u32 v27, s57, v21
    v_add_u32 v28, s57, v22
    v_mfma_f32_32x32x16_bf16 v[160:175], v[234:237], v[222:225], v[128:143]
    s_waitcnt lgkmcnt(1)
    ds_read_b128 v[234:237], v27 offset:0
    v_exp_f32 v101, v101
    v_exp_f32 v102, v102
    v_exp_f32 v103, v103
    v_mfma_f32_32x32x8_bf16 v[160:175], v[244:245], v[230:231], v[160:175]
    v_exp_f32 v104, v104
    v_exp_f32 v105, v105
    v_exp_f32 v106, v106
    v_exp_f32 v107, v107
    v_exp_f32 v108, v108
    v_exp_f32 v109, v109
    v_smfmac_f32_32x32x32_bf16 v[176:191], v[246:249], v[96:103], v20
    v_exp_f32 v110, v110
    v_exp_f32 v111, v111
    v_exp_f32 v160, v160
    v_exp_f32 v161, v161
    v_smfmac_f32_32x32x32_bf16 v[176:191], v[208:211], v[104:111], v20
    s_add_u32 s56, s56, 1
    v_exp_f32 v162, v162
    v_exp_f32 v163, v163
    v_exp_f32 v164, v164
    v_mfma_f32_32x32x16_bf16 v[96:111], v[238:241], v[218:221], v[112:127]
    ds_read_b128 v[250:253], v29 offset:21472
    v_exp_f32 v165, v165
    v_exp_f32 v166, v166
    v_exp_f32 v167, v167
    v_mfma_f32_32x32x8_bf16 v[96:111], v[244:245], v[228:229], v[96:111]
    v_exp_f32 v168, v168
    v_exp_f32 v169, v169
    v_exp_f32 v170, v170
    v_exp_f32 v171, v171
    v_exp_f32 v172, v172
    v_exp_f32 v173, v173
    v_smfmac_f32_32x32x32_bf16 v[192:207], v[246:249], v[160:167], v20
    ds_read_b64 v[242:243], v28 offset:8192
    v_exp_f32 v174, v174
    v_exp_f32 v175, v175
    v_add_u32 v29, s57, v23
    v_exp_f32 v96, v96
    v_exp_f32 v97, v97
    v_smfmac_f32_32x32x32_bf16 v[192:207], v[208:211], v[168:175], v20
    ds_read_b128 v[208:211], v29 offset:12944
    v_exp_f32 v98, v98
    v_exp_f32 v99, v99
    v_exp_f32 v100, v100
    v_mfma_f32_32x32x16_bf16 v[160:175], v[238:241], v[222:225], v[128:143]
    s_waitcnt lgkmcnt(2)
    ds_read_b128 v[238:241], v27 offset:1024
    v_exp_f32 v101, v101
    v_exp_f32 v102, v102
    v_exp_f32 v103, v103
    v_mfma_f32_32x32x8_bf16 v[160:175], v[244:245], v[232:233], v[160:175]
    v_exp_f32 v104, v104
    v_exp_f32 v105, v105
    v_exp_f32 v106, v106
    v_exp_f32 v107, v107
    v_exp_f32 v108, v108
    v_exp_f32 v109, v109
    v_smfmac_f32_32x32x32_bf16 v[176:191], v[250:253], v[96:103], v20
    v_exp_f32 v110, v110
    v_exp_f32 v111, v111
    v_exp_f32 v160, v160
    v_exp_f32 v161, v161
    v_smfmac_f32_32x32x32_bf16 v[176:191], v[212:215], v[104:111], v20
    v_exp_f32 v162, v162
    v_exp_f32 v163, v163
    v_exp_f32 v164, v164
    v_mfma_f32_32x32x16_bf16 v[96:111], v[234:237], v[218:221], v[112:127]
    s_waitcnt lgkmcnt(2)
    ds_read_b128 v[246:249], v29 offset:12288
    v_exp_f32 v165, v165
    v_exp_f32 v166, v166
    v_exp_f32 v167, v167
    v_mfma_f32_32x32x8_bf16 v[96:111], v[242:243], v[226:227], v[96:111]
    v_exp_f32 v168, v168
    v_exp_f32 v169, v169
    v_exp_f32 v170, v170
    v_exp_f32 v171, v171
    v_exp_f32 v172, v172
    v_exp_f32 v173, v173
    v_smfmac_f32_32x32x32_bf16 v[192:207], v[250:253], v[160:167], v20
    s_cmp_lt_u32 s56, 8
    s_cbranch_scc1 L_aloop
    v_exp_f32 v174, v174
    v_exp_f32 v175, v175
    v_rcp_f32 v189, v188
    s_waitcnt lgkmcnt(0)
    v_smfmac_f32_32x32x32_bf16 v[192:207], v[212:215], v[168:175], v20
    s_barrier
    s_mov_b32 s58, 2122317824
    s_mov_b32 s59, 234881024
    v_maximum3_f32 v4, |v176|, |v177|, |v178|
    v_maximum3_f32 v4, v4, |v179|, |v180|
    v_maximum3_f32 v4, v4, |v181|, |v182|
    v_maximum3_f32 v4, v4, |v183|, |v184|
    v_maximum3_f32 v4, v4, |v185|, |v186|
    v_maximum3_f32 v4, v4, |v187|, |v187|
    v_pk_mul_f32 v[176:177], v[176:177], v[188:189] op_sel:[0,1] op_sel_hi:[1,1]
    v_pk_mul_f32 v[178:179], v[178:179], v[188:189] op_sel:[0,1] op_sel_hi:[1,1]
    v_pk_mul_f32 v[180:181], v[180:181], v[188:189] op_sel:[0,1] op_sel_hi:[1,1]
    v_pk_mul_f32 v[182:183], v[182:183], v[188:189] op_sel:[0,1] op_sel_hi:[1,1]
    v_pk_mul_f32 v[184:185], v[184:185], v[188:189] op_sel:[0,1] op_sel_hi:[1,1]
    v_pk_mul_f32 v[186:187], v[186:187], v[188:189] op_sel:[0,1] op_sel_hi:[1,1]
    v_cvt_pk_bf16_f32 v112, v176, v177
    v_cvt_pk_bf16_f32 v113, v178, v179
    v_cvt_pk_bf16_f32 v114, v180, v181
    v_cvt_pk_bf16_f32 v115, v182, v183
    v_cvt_pk_bf16_f32 v116, v184, v185
    v_cvt_pk_bf16_f32 v117, v186, v187
    v_rcp_f32 v205, v204
    v_maximum3_f32 v5, |v192|, |v193|, |v194|
    v_maximum3_f32 v5, v5, |v195|, |v196|
    v_maximum3_f32 v5, v5, |v197|, |v198|
    v_maximum3_f32 v5, v5, |v199|, |v200|
    v_maximum3_f32 v5, v5, |v201|, |v202|
    v_maximum3_f32 v5, v5, |v203|, |v203|
    v_maximum3_f32 v6, v4, v5, v188
    v_min_f32 v4, v4, v5
    v_maximum3_f32 v6, v6, v204, v204
    v_cmp_le_f32 vcc, s59, v4
    v_cmp_gt_f32 s[60:61], s58, v6
    s_add_u32 s58, s52, 12320768
    s_add_u32 s59, s53, 12320768
    s_and_b64 vcc, vcc, s[60:61]
    s_cmp_eq_u64 vcc, exec
    s_cbranch_scc0 L_slow
    buffer_store_dwordx4 v[112:115], v24, s[24:27], s58 offen offset:0 sc1
    s_mov_b32 exec_hi, 0
    buffer_store_dwordx2 v[116:117], v25, s[24:27], s59 offen offset:0 sc1
    s_mov_b32 exec_hi, -1
    v_pk_mul_f32 v[192:193], v[192:193], v[204:205] op_sel:[0,1] op_sel_hi:[1,1]
    v_pk_mul_f32 v[194:195], v[194:195], v[204:205] op_sel:[0,1] op_sel_hi:[1,1]
    v_pk_mul_f32 v[196:197], v[196:197], v[204:205] op_sel:[0,1] op_sel_hi:[1,1]
    v_pk_mul_f32 v[198:199], v[198:199], v[204:205] op_sel:[0,1] op_sel_hi:[1,1]
    v_pk_mul_f32 v[200:201], v[200:201], v[204:205] op_sel:[0,1] op_sel_hi:[1,1]
    v_pk_mul_f32 v[202:203], v[202:203], v[204:205] op_sel:[0,1] op_sel_hi:[1,1]
    v_cvt_pk_bf16_f32 v128, v192, v193
    v_cvt_pk_bf16_f32 v129, v194, v195
    v_cvt_pk_bf16_f32 v130, v196, v197
    v_cvt_pk_bf16_f32 v131, v198, v199
    v_cvt_pk_bf16_f32 v132, v200, v201
    v_cvt_pk_bf16_f32 v133, v202, v203
L_norm:
    buffer_store_dwordx4 v[128:131], v24, s[24:27], s58 offen offset:512 sc1
    s_mov_b32 exec_hi, 0
    buffer_store_dwordx2 v[132:133], v25, s[24:27], s59 offen offset:512 sc1
    s_mov_b32 exec_hi, -1
    s_barrier
    s_endpgm
L_hk:
    s_waitcnt vmcnt(0)
    s_lshl_b32 s58, s70, 7
    s_add_u32 s58, s58, 20875264
    v_lshlrev_b32 v6, 2, v1
    v_mov_b32 v5, s55
    s_mov_b32 exec_hi, 0
    buffer_store_dword v5, v6, s[24:27], s58 offen sc1
    s_mov_b64 exec, -1
    s_branch L_hk_r
L_slow:
    v_and_b32 v2, 31, v1
    v_lshrrev_b32 v3, 5, v1
    v_bfe_u32 v5, v2, 2, 1
    v_bfe_u32 v6, v2, 3, 2
    v_lshl_add_u32 v5, v5, 2, v6
    v_and_b32 v6, 3, v2
    v_lshl_add_u32 v4, v5, 2, v6
    s_lshl_b32 s58, s54, 3
    s_add_u32 s58, s58, s53
    v_lshl_add_u32 v28, v4, 4, s58
    v_lshl_add_u32 v8, v4, 4, s52
    v_lshl_add_u32 v8, v3, 15, v8
    v_lshrrev_b32 v5, 1, v2
    v_xor_b32 v5, v5, v2
    v_and_b32 v5, 4, v5
    v_lshlrev_b32 v6, 1, v5
    v_or_b32 v5, v5, v6
    v_xor_b32 v4, v5, v2
    s_lshl_b32 s58, s54, 2
    s_mul_i32 s59, s54, -16
    v_cmp_gt_u32 vcc, 16, v2
    v_add_u32 v4, s58, v4
    v_add_u32 v5, s59, v2
    v_cndmask_b32 v4, v5, v4, vcc
    s_mul_i32 s58, s48, 320
    v_mul_u32_u24 v6, 10240, v3
    v_lshl_add_u32 v4, v4, 4, v6
    v_add_u32 v29, s58, v4
    v_mov_b32 v216, 0xff800000
    v_mov_b32 v217, 0xff800000
    s_mov_b32 s66, 2621440
L_slow1:
    buffer_load_dwordx4 v[234:237], v8, s[24:27], s66 offen sc1
    buffer_load_dwordx2 v[242:243], v28, s[24:27], s66 offen sc1
    s_add_u32 s66, s66, 512
    s_waitcnt vmcnt(0)
    v_mfma_f32_32x32x16_bf16 v[96:111], v[234:237], v[218:221], 0
    v_mfma_f32_32x32x8_bf16 v[96:111], v[242:243], v[226:227], v[96:111]
    v_mfma_f32_32x32x16_bf16 v[160:175], v[234:237], v[222:225], 0
    v_mfma_f32_32x32x8_bf16 v[160:175], v[242:243], v[230:231], v[160:175]
    s_nop 7
    s_nop 3
    v_max3_f32 v216, v216, v96, v97
    v_max3_f32 v216, v216, v98, v99
    v_max3_f32 v216, v216, v100, v101
    v_max3_f32 v216, v216, v102, v103
    v_max3_f32 v216, v216, v104, v105
    v_max3_f32 v216, v216, v106, v107
    v_max3_f32 v216, v216, v108, v109
    v_max3_f32 v216, v216, v110, v111
    v_max3_f32 v217, v217, v160, v161
    v_max3_f32 v217, v217, v162, v163
    v_max3_f32 v217, v217, v164, v165
    v_max3_f32 v217, v217, v166, v167
    v_max3_f32 v217, v217, v168, v169
    v_max3_f32 v217, v217, v170, v171
    v_max3_f32 v217, v217, v172, v173
    v_max3_f32 v217, v217, v174, v175
    s_cmp_lt_u32 s66, 2654208
    s_cbranch_scc1 L_slow1
    v_mov_b32 v4, v216
    s_nop 1
    v_permlane32_swap_b32 v216, v4
    v_max_f32 v216, v216, v4
    v_sub_f32 v112, 0, v216
    v_mov_b32 v113, v112
    v_mov_b64 v[114:115], v[112:113]
    v_mov_b64 v[116:117], v[112:113]
    v_mov_b64 v[118:119], v[112:113]
    v_mov_b64 v[120:121], v[112:113]
    v_mov_b64 v[122:123], v[112:113]
    v_mov_b64 v[124:125], v[112:113]
    v_mov_b64 v[126:127], v[112:113]
    v_mov_b32 v4, v217
    s_nop 1
    v_permlane32_swap_b32 v217, v4
    v_max_f32 v217, v217, v4
    v_sub_f32 v128, 0, v217
    v_mov_b32 v129, v128
    v_mov_b64 v[130:131], v[128:129]
    v_mov_b64 v[132:133], v[128:129]
    v_mov_b64 v[134:135], v[128:129]
    v_mov_b64 v[136:137], v[128:129]
    v_mov_b64 v[138:139], v[128:129]
    v_mov_b64 v[140:141], v[128:129]
    v_mov_b64 v[142:143], v[128:129]
    v_mov_b64 v[176:177], 0
    v_mov_b64 v[178:179], 0
    v_mov_b64 v[180:181], 0
    v_mov_b64 v[182:183], 0
    v_mov_b64 v[184:185], 0
    v_mov_b64 v[186:187], 0
    v_mov_b64 v[188:189], 0
    v_mov_b64 v[190:191], 0
    v_mov_b64 v[192:193], 0
    v_mov_b64 v[194:195], 0
    v_mov_b64 v[196:197], 0
    v_mov_b64 v[198:199], 0
    v_mov_b64 v[200:201], 0
    v_mov_b64 v[202:203], 0
    v_mov_b64 v[204:205], 0
    v_mov_b64 v[206:207], 0
    v_mov_b32 v246, 0x3f803f80
    v_mov_b32 v208, 0x3f803f80
    v_mov_b32 v247, 0x3f803f80
    v_mov_b32 v209, 0x3f803f80
    v_mov_b32 v248, 0x3f803f80
    v_mov_b32 v210, 0x3f803f80
    v_mov_b32 v249, 0x3f803f80
    v_mov_b32 v211, 0x3f803f80
    s_mov_b32 s66, 2621440
    s_mov_b32 s67, 14942208
L_slow2:
    buffer_load_dwordx4 v[234:237], v8, s[24:27], s66 offen sc1
    buffer_load_dwordx2 v[242:243], v28, s[24:27], s66 offen sc1
    s_mov_b32 exec_lo, 0xfffff
    s_mov_b32 exec_hi, 0xfffff
    buffer_load_dwordx4 v[246:249], v29, s[24:27], s67 offen sc1
    s_add_u32 s67, s67, 20480
    buffer_load_dwordx4 v[208:211], v29, s[24:27], s67 offen sc1
    s_mov_b64 exec, -1
    s_add_u32 s67, s67, 20480
    s_add_u32 s66, s66, 512
    s_waitcnt vmcnt(0)
    v_mfma_f32_32x32x16_bf16 v[96:111], v[234:237], v[218:221], v[112:127]
    v_mfma_f32_32x32x8_bf16 v[96:111], v[242:243], v[226:227], v[96:111]
    v_mfma_f32_32x32x16_bf16 v[160:175], v[234:237], v[222:225], v[128:143]
    v_mfma_f32_32x32x8_bf16 v[160:175], v[242:243], v[230:231], v[160:175]
    s_nop 7
    s_nop 3
    v_exp_f32 v96, v96
    v_exp_f32 v97, v97
    v_exp_f32 v98, v98
    v_exp_f32 v99, v99
    v_exp_f32 v100, v100
    v_exp_f32 v101, v101
    v_exp_f32 v102, v102
    v_exp_f32 v103, v103
    v_exp_f32 v104, v104
    v_exp_f32 v105, v105
    v_exp_f32 v106, v106
    v_exp_f32 v107, v107
    v_exp_f32 v108, v108
    v_exp_f32 v109, v109
    v_exp_f32 v110, v110
    v_exp_f32 v111, v111
    v_exp_f32 v160, v160
    v_exp_f32 v161, v161
    v_exp_f32 v162, v162
    v_exp_f32 v163, v163
    v_exp_f32 v164, v164
    v_exp_f32 v165, v165
    v_exp_f32 v166, v166
    v_exp_f32 v167, v167
    v_exp_f32 v168, v168
    v_exp_f32 v169, v169
    v_exp_f32 v170, v170
    v_exp_f32 v171, v171
    v_exp_f32 v172, v172
    v_exp_f32 v173, v173
    v_exp_f32 v174, v174
    v_exp_f32 v175, v175
    s_nop 1
    v_smfmac_f32_32x32x32_bf16 v[176:191], v[246:249], v[96:103], v20
    v_smfmac_f32_32x32x32_bf16 v[176:191], v[208:211], v[104:111], v20
    v_smfmac_f32_32x32x32_bf16 v[192:207], v[246:249], v[160:167], v20
    v_smfmac_f32_32x32x32_bf16 v[192:207], v[208:211], v[168:175], v20
    s_cmp_lt_u32 s66, 2654208
    s_cbranch_scc1 L_slow2
    s_nop 7
    s_nop 3
    v_rcp_f32 v189, v188
    v_rcp_f32 v205, v204
    s_add_u32 s58, s52, 12320768
    s_add_u32 s59, s53, 12320768
    v_pk_mul_f32 v[176:177], v[176:177], v[188:189] op_sel:[0,1] op_sel_hi:[1,1]
    v_pk_mul_f32 v[178:179], v[178:179], v[188:189] op_sel:[0,1] op_sel_hi:[1,1]
    v_pk_mul_f32 v[180:181], v[180:181], v[188:189] op_sel:[0,1] op_sel_hi:[1,1]
    v_pk_mul_f32 v[182:183], v[182:183], v[188:189] op_sel:[0,1] op_sel_hi:[1,1]
    v_pk_mul_f32 v[184:185], v[184:185], v[188:189] op_sel:[0,1] op_sel_hi:[1,1]
    v_pk_mul_f32 v[186:187], v[186:187], v[188:189] op_sel:[0,1] op_sel_hi:[1,1]
    v_cvt_pk_bf16_f32 v112, v176, v177
    v_cvt_pk_bf16_f32 v113, v178, v179
    v_cvt_pk_bf16_f32 v114, v180, v181
    v_cvt_pk_bf16_f32 v115, v182, v183
    v_cvt_pk_bf16_f32 v116, v184, v185
    v_cvt_pk_bf16_f32 v117, v186, v187
    v_min_u32 v113, -2, v113
    v_min_u32 v115, -2, v115
    v_min_u32 v117, -2, v117
    v_pk_mul_f32 v[192:193], v[192:193], v[204:205] op_sel:[0,1] op_sel_hi:[1,1]
    v_pk_mul_f32 v[194:195], v[194:195], v[204:205] op_sel:[0,1] op_sel_hi:[1,1]
    v_pk_mul_f32 v[196:197], v[196:197], v[204:205] op_sel:[0,1] op_sel_hi:[1,1]
    v_pk_mul_f32 v[198:199], v[198:199], v[204:205] op_sel:[0,1] op_sel_hi:[1,1]
    v_pk_mul_f32 v[200:201], v[200:201], v[204:205] op_sel:[0,1] op_sel_hi:[1,1]
    v_pk_mul_f32 v[202:203], v[202:203], v[204:205] op_sel:[0,1] op_sel_hi:[1,1]
    v_cvt_pk_bf16_f32 v128, v192, v193
    v_cvt_pk_bf16_f32 v129, v194, v195
    v_cvt_pk_bf16_f32 v130, v196, v197
    v_cvt_pk_bf16_f32 v131, v198, v199
    v_cvt_pk_bf16_f32 v132, v200, v201
    v_cvt_pk_bf16_f32 v133, v202, v203
    v_min_u32 v129, -2, v129
    v_min_u32 v131, -2, v131
    v_min_u32 v133, -2, v133
    buffer_store_dwordx4 v[112:115], v24, s[24:27], s58 offen offset:0 sc1
    s_mov_b32 exec_hi, 0
    buffer_store_dwordx2 v[116:117], v25, s[24:27], s59 offen offset:0 sc1
    s_mov_b32 exec_hi, -1
    s_branch L_norm
L_near:
    s_lshl_b32 s58, s46, 3
    s_add_u32 s58, s58, s44
    s_mul_i32 s59, s58, 3328
    s_add_u32 s59, s59, 20744192
    v_lshlrev_b32 v4, 7, v1
    s_mov_b64 s[36:37], s[22:23]
    s_mov_b32 s38, 21170304
    s_mov_b64 exec, 0x3ffffff
    buffer_load_dword v95, v4, s[36:39], s59 offen
    s_mov_b64 exec, -1
    s_mov_b64 s[36:37], s[18:19]
    s_mov_b32 s38, 1280
    buffer_load_dword v92, v4, s[36:39], 0 offen
    s_setprio 0
    s_lshl_b32 s10, s44, 4
    s_add_u32 s10, s10, s46
    v_add_u32 v4, 0, v1
    v_mul_u32_u24 v5, 3277, v4
    v_lshrrev_b32 v5, 16, v5
    v_mul_u32_u24 v5, 960, v5
    v_lshl_add_u32 v228, v4, 4, v5
    v_add_u32 v4, 64, v1
    v_mul_u32_u24 v5, 3277, v4
    v_lshrrev_b32 v5, 16, v5
    v_mul_u32_u24 v5, 960, v5
    v_lshl_add_u32 v229, v4, 4, v5
    v_add_u32 v4, 128, v1
    v_mul_u32_u24 v5, 3277, v4
    v_lshrrev_b32 v5, 16, v5
    v_mul_u32_u24 v5, 960, v5
    v_lshl_add_u32 v230, v4, 4, v5
    v_add_u32 v4, 192, v1
    v_mul_u32_u24 v5, 3277, v4
    v_lshrrev_b32 v5, 16, v5
    v_mul_u32_u24 v5, 960, v5
    v_lshl_add_u32 v231, v4, 4, v5
    v_add_u32 v4, 256, v1
    v_mul_u32_u24 v5, 3277, v4
    v_lshrrev_b32 v5, 16, v5
    v_mul_u32_u24 v5, 960, v5
    v_lshl_add_u32 v232, v4, 4, v5
    s_mul_i32 s69, s44, 20480
    s_mov_b32 s35, 0x00020000
    s_lshl_b32 s60, s10, 1
    s_add_u32 s60, s60, 0
    s_lshr_b32 s58, s60, 2
    s_cmp_lt_u32 s58, 54
    s_cselect_b32 s32, s16, s8
    s_cselect_b32 s33, s17, s9
    s_mov_b32 s34, 2211840
    s_cselect_b32 s34, s34, 819200
    s_cselect_b32 s59, 0, 54
    s_sub_u32 s58, s58, s59
    s_mul_i32 s63, s58, 40960
    s_and_b32 s59, s60, 3
    s_mul_i32 s59, s59, 320
    s_add_u32 s63, s63, s59
    s_add_u32 m0, s69, 0
    s_nop 0
    buffer_load_dwordx4 v228, s[32:35], s63 offen lds
    s_add_u32 m0, s69, 1024
    s_nop 0
    buffer_load_dwordx4 v229, s[32:35], s63 offen lds
    s_add_u32 m0, s69, 2048
    s_nop 0
    buffer_load_dwordx4 v230, s[32:35], s63 offen lds
    s_add_u32 m0, s69, 3072
    s_nop 0
    buffer_load_dwordx4 v231, s[32:35], s63 offen lds
    s_add_u32 m0, s69, 4096
    s_nop 0
    buffer_load_dwordx4 v232, s[32:35], s63 offen lds
    s_add_u32 s63, s63, 20480
    s_add_u32 m0, s69, 5120
    s_nop 0
    buffer_load_dwordx4 v228, s[32:35], s63 offen lds
    s_add_u32 m0, s69, 6144
    s_nop 0
    buffer_load_dwordx4 v229, s[32:35], s63 offen lds
    s_add_u32 m0, s69, 7168
    s_nop 0
    buffer_load_dwordx4 v230, s[32:35], s63 offen lds
    s_add_u32 m0, s69, 8192
    s_nop 0
    buffer_load_dwordx4 v231, s[32:35], s63 offen lds
    s_add_u32 m0, s69, 9216
    s_nop 0
    buffer_load_dwordx4 v232, s[32:35], s63 offen lds
    s_add_u32 s63, s63, 20480
    s_lshl_b32 s60, s10, 1
    s_add_u32 s60, s60, 1
    s_lshr_b32 s58, s60, 2
    s_cmp_lt_u32 s58, 54
    s_cselect_b32 s32, s16, s8
    s_cselect_b32 s33, s17, s9
    s_mov_b32 s34, 2211840
    s_cselect_b32 s34, s34, 819200
    s_cselect_b32 s59, 0, 54
    s_sub_u32 s58, s58, s59
    s_mul_i32 s63, s58, 40960
    s_and_b32 s59, s60, 3
    s_mul_i32 s59, s59, 320
    s_add_u32 s63, s63, s59
    s_add_u32 m0, s69, 10240
    s_nop 0
    buffer_load_dwordx4 v228, s[32:35], s63 offen lds
    s_add_u32 m0, s69, 11264
    s_nop 0
    buffer_load_dwordx4 v229, s[32:35], s63 offen lds
    s_add_u32 m0, s69, 12288
    s_nop 0
    buffer_load_dwordx4 v230, s[32:35], s63 offen lds
    s_add_u32 m0, s69, 13312
    s_nop 0
    buffer_load_dwordx4 v231, s[32:35], s63 offen lds
    s_add_u32 m0, s69, 14336
    s_nop 0
    buffer_load_dwordx4 v232, s[32:35], s63 offen lds
    s_add_u32 s63, s63, 20480
    s_add_u32 m0, s69, 15360
    s_nop 0
    buffer_load_dwordx4 v228, s[32:35], s63 offen lds
    s_add_u32 m0, s69, 16384
    s_nop 0
    buffer_load_dwordx4 v229, s[32:35], s63 offen lds
    s_add_u32 m0, s69, 17408
    s_nop 0
    buffer_load_dwordx4 v230, s[32:35], s63 offen lds
    s_add_u32 m0, s69, 18432
    s_nop 0
    buffer_load_dwordx4 v231, s[32:35], s63 offen lds
    s_add_u32 m0, s69, 19456
    s_nop 0
    buffer_load_dwordx4 v232, s[32:35], s63 offen lds
    s_add_u32 s63, s63, 20480
    s_branch L_p_go
L_tr:
    v_add_u32 v4, 0, v1
    v_mul_u32_u24 v5, 3277, v4
    v_lshrrev_b32 v5, 16, v5
    v_mul_u32_u24 v5, 960, v5
    v_lshl_add_u32 v228, v4, 4, v5
    v_add_u32 v4, 64, v1
    v_mul_u32_u24 v5, 3277, v4
    v_lshrrev_b32 v5, 16, v5
    v_mul_u32_u24 v5, 960, v5
    v_lshl_add_u32 v229, v4, 4, v5
    v_add_u32 v4, 128, v1
    v_mul_u32_u24 v5, 3277, v4
    v_lshrrev_b32 v5, 16, v5
    v_mul_u32_u24 v5, 960, v5
    v_lshl_add_u32 v230, v4, 4, v5
    v_add_u32 v4, 192, v1
    v_mul_u32_u24 v5, 3277, v4
    v_lshrrev_b32 v5, 16, v5
    v_mul_u32_u24 v5, 960, v5
    v_lshl_add_u32 v231, v4, 4, v5
    v_add_u32 v4, 256, v1
    v_mul_u32_u24 v5, 3277, v4
    v_lshrrev_b32 v5, 16, v5
    v_mul_u32_u24 v5, 960, v5
    v_lshl_add_u32 v232, v4, 4, v5
    s_mul_i32 s69, s44, 20480
    s_mov_b32 s35, 0x00020000
    s_add_u32 s40, s22, 17563648
    s_addc_u32 s41, s23, 0
    s_mov_b32 s42, 3031040
    s_mov_b32 s43, 0x00020000
    s_mul_i32 s71, s10, 20480
    s_add_u32 s72, s71, 10240
    s_mul_i32 s73, s10, 10240
    s_add_u32 s73, s73, 2621440
    v_lshrrev_b32 v2, 4, v1
    v_bfe_u32 v3, v1, 2, 2
    v_lshl_add_u32 v2, v2, 3, v3
    v_mul_u32_u24 v2, 320, v2
    v_add_u32 v2, s69, v2
    v_and_b32 v3, 3, v1
    v_lshl_add_u32 v11, v3, 4, v2
    v_lshl_add_u32 v12, v3, 3, v2
    v_lshlrev_b32 v33, 4, v1
    v_add_u32 v34, 4096, v33
    v_add_u32 v35, 8192, v33
    s_waitcnt vmcnt(0)
    ds_read_b64_tr_b16 v[40:41], v11 offset:0
    ds_read_b64_tr_b16 v[42:43], v11 offset:1280
    ds_read_b64_tr_b16 v[44:45], v11 offset:8
    ds_read_b64_tr_b16 v[46:47], v11 offset:1288
    ds_read_b64_tr_b16 v[48:49], v11 offset:64
    ds_read_b64_tr_b16 v[50:51], v11 offset:1344
    ds_read_b64_tr_b16 v[52:53], v11 offset:72
    ds_read_b64_tr_b16 v[54:55], v11 offset:1352
    ds_read_b64_tr_b16 v[56:57], v12 offset:128
    ds_read_b64_tr_b16 v[58:59], v12 offset:1408
    s_waitcnt lgkmcnt(0)
    ds_read_b64_tr_b16 v[60:61], v11 offset:160
    ds_read_b64_tr_b16 v[62:63], v11 offset:1440
    ds_read_b64_tr_b16 v[64:65], v11 offset:168
    ds_read_b64_tr_b16 v[66:67], v11 offset:1448
    ds_read_b64_tr_b16 v[68:69], v11 offset:224
    ds_read_b64_tr_b16 v[70:71], v11 offset:1504
    ds_read_b64_tr_b16 v[72:73], v11 offset:232
    ds_read_b64_tr_b16 v[74:75], v11 offset:1512
    ds_read_b64_tr_b16 v[76:77], v12 offset:288
    ds_read_b64_tr_b16 v[78:79], v12 offset:1568
    s_waitcnt lgkmcnt(0)
    s_cmp_lt_u32 s10, 40
    s_cbranch_scc0 L_tr2
    s_add_u32 s60, s10, 256
    s_lshr_b32 s58, s60, 2
    s_cmp_lt_u32 s58, 54
    s_cselect_b32 s32, s16, s8
    s_cselect_b32 s33, s17, s9
    s_mov_b32 s34, 2211840
    s_cselect_b32 s34, s34, 819200
    s_cselect_b32 s59, 0, 54
    s_sub_u32 s58, s58, s59
    s_mul_i32 s63, s58, 40960
    s_and_b32 s59, s60, 3
    s_mul_i32 s59, s59, 320
    s_add_u32 s63, s63, s59
    s_add_u32 m0, s69, 0
    s_nop 0
    buffer_load_dwordx4 v228, s[32:35], s63 offen lds
    s_add_u32 m0, s69, 1024
    s_nop 0
    buffer_load_dwordx4 v229, s[32:35], s63 offen lds
    s_add_u32 m0, s69, 2048
    s_nop 0
    buffer_load_dwordx4 v230, s[32:35], s63 offen lds
    s_add_u32 m0, s69, 3072
    s_nop 0
    buffer_load_dwordx4 v231, s[32:35], s63 offen lds
    s_add_u32 m0, s69, 4096
    s_nop 0
    buffer_load_dwordx4 v232, s[32:35], s63 offen lds
    s_add_u32 s63, s63, 20480
    s_add_u32 m0, s69, 5120
    s_nop 0
    buffer_load_dwordx4 v228, s[32:35], s63 offen lds
    s_add_u32 m0, s69, 6144
    s_nop 0
    buffer_load_dwordx4 v229, s[32:35], s63 offen lds
    s_add_u32 m0, s69, 7168
    s_nop 0
    buffer_load_dwordx4 v230, s[32:35], s63 offen lds
    s_add_u32 m0, s69, 8192
    s_nop 0
    buffer_load_dwordx4 v231, s[32:35], s63 offen lds
    s_add_u32 m0, s69, 9216
    s_nop 0
    buffer_load_dwordx4 v232, s[32:35], s63 offen lds
    s_add_u32 s63, s63, 20480
L_tr2:
    ds_read_b64_tr_b16 v[80:81], v11 offset:10240
    ds_read_b64_tr_b16 v[82:83], v11 offset:11520
    ds_read_b64_tr_b16 v[84:85], v11 offset:10248
    ds_read_b64_tr_b16 v[86:87], v11 offset:11528
    ds_read_b64_tr_b16 v[88:89], v11 offset:10304
    ds_read_b64_tr_b16 v[90:91], v11 offset:11584
    ds_read_b64_tr_b16 v[92:93], v11 offset:10312
    ds_read_b64_tr_b16 v[94:95], v11 offset:11592
    ds_read_b64_tr_b16 v[96:97], v12 offset:10368
    ds_read_b64_tr_b16 v[98:99], v12 offset:11648
    s_waitcnt lgkmcnt(0)
    ds_read_b64_tr_b16 v[100:101], v11 offset:10400
    ds_read_b64_tr_b16 v[102:103], v11 offset:11680
    ds_read_b64_tr_b16 v[104:105], v11 offset:10408
    ds_read_b64_tr_b16 v[106:107], v11 offset:11688
    ds_read_b64_tr_b16 v[108:109], v11 offset:10464
    ds_read_b64_tr_b16 v[110:111], v11 offset:11744
    ds_read_b64_tr_b16 v[112:113], v11 offset:10472
    ds_read_b64_tr_b16 v[114:115], v11 offset:11752
    ds_read_b64_tr_b16 v[116:117], v12 offset:10528
    ds_read_b64_tr_b16 v[118:119], v12 offset:11808
    s_waitcnt lgkmcnt(0)
    s_barrier
    buffer_store_dwordx4 v[40:43], v33, s[40:43], s71 offen offset:0 sc1
    buffer_store_dwordx4 v[44:47], v33, s[40:43], s71 offen offset:1024 sc1
    buffer_store_dwordx4 v[48:51], v33, s[40:43], s71 offen offset:2048 sc1
    buffer_store_dwordx4 v[52:55], v33, s[40:43], s71 offen offset:3072 sc1
    buffer_store_dwordx4 v[56:59], v34, s[40:43], s71 offen offset:0 sc1
    buffer_store_dwordx4 v[60:63], v34, s[40:43], s71 offen offset:1024 sc1
    buffer_store_dwordx4 v[64:67], v34, s[40:43], s71 offen offset:2048 sc1
    buffer_store_dwordx4 v[68:71], v34, s[40:43], s71 offen offset:3072 sc1
    buffer_store_dwordx4 v[72:75], v35, s[40:43], s71 offen offset:0 sc1
    buffer_store_dwordx4 v[76:79], v35, s[40:43], s71 offen offset:1024 sc1
    buffer_store_dwordx4 v[80:83], v33, s[40:43], s72 offen offset:0 sc1
    buffer_store_dwordx4 v[84:87], v33, s[40:43], s72 offen offset:1024 sc1
    buffer_store_dwordx4 v[88:91], v33, s[40:43], s72 offen offset:2048 sc1
    buffer_store_dwordx4 v[92:95], v33, s[40:43], s72 offen offset:3072 sc1
    buffer_store_dwordx4 v[96:99], v34, s[40:43], s72 offen offset:0 sc1
    buffer_store_dwordx4 v[100:103], v34, s[40:43], s72 offen offset:1024 sc1
    buffer_store_dwordx4 v[104:107], v34, s[40:43], s72 offen offset:2048 sc1
    buffer_store_dwordx4 v[108:111], v34, s[40:43], s72 offen offset:3072 sc1
    buffer_store_dwordx4 v[112:115], v35, s[40:43], s72 offen offset:0 sc1
    buffer_store_dwordx4 v[116:119], v35, s[40:43], s72 offen offset:1024 sc1
    s_cmp_lt_u32 s10, 40
    s_cbranch_scc0 L_tr3
    s_waitcnt vmcnt(20)
    ds_read_b64_tr_b16 v[120:121], v11 offset:0
    ds_read_b64_tr_b16 v[122:123], v11 offset:1280
    ds_read_b64_tr_b16 v[124:125], v11 offset:8
    ds_read_b64_tr_b16 v[126:127], v11 offset:1288
    ds_read_b64_tr_b16 v[128:129], v11 offset:64
    ds_read_b64_tr_b16 v[130:131], v11 offset:1344
    ds_read_b64_tr_b16 v[132:133], v11 offset:72
    ds_read_b64_tr_b16 v[134:135], v11 offset:1352
    ds_read_b64_tr_b16 v[136:137], v12 offset:128
    ds_read_b64_tr_b16 v[138:139], v12 offset:1408
    s_waitcnt lgkmcnt(0)
    ds_read_b64_tr_b16 v[140:141], v11 offset:160
    ds_read_b64_tr_b16 v[142:143], v11 offset:1440
    ds_read_b64_tr_b16 v[144:145], v11 offset:168
    ds_read_b64_tr_b16 v[146:147], v11 offset:1448
    ds_read_b64_tr_b16 v[148:149], v11 offset:224
    ds_read_b64_tr_b16 v[150:151], v11 offset:1504
    ds_read_b64_tr_b16 v[152:153], v11 offset:232
    ds_read_b64_tr_b16 v[154:155], v11 offset:1512
    ds_read_b64_tr_b16 v[156:157], v12 offset:288
    ds_read_b64_tr_b16 v[158:159], v12 offset:1568
    s_waitcnt lgkmcnt(0)
    buffer_store_dwordx4 v[120:123], v33, s[40:43], s73 offen offset:0 sc1
    buffer_store_dwordx4 v[124:127], v33, s[40:43], s73 offen offset:1024 sc1
    buffer_store_dwordx4 v[128:131], v33, s[40:43], s73 offen offset:2048 sc1
    buffer_store_dwordx4 v[132:135], v33, s[40:43], s73 offen offset:3072 sc1
    buffer_store_dwordx4 v[136:139], v34, s[40:43], s73 offen offset:0 sc1
    buffer_store_dwordx4 v[140:143], v34, s[40:43], s73 offen offset:1024 sc1
    buffer_store_dwordx4 v[144:147], v34, s[40:43], s73 offen offset:2048 sc1
    buffer_store_dwordx4 v[148:151], v34, s[40:43], s73 offen offset:3072 sc1
    buffer_store_dwordx4 v[152:155], v35, s[40:43], s73 offen offset:0 sc1
    buffer_store_dwordx4 v[156:159], v35, s[40:43], s73 offen offset:1024 sc1
L_tr3:
    s_cmp_eq_u32 s3, 1
    s_waitcnt vmcnt(0)
    s_barrier
    s_cbranch_scc1 L_tr_f
    s_branch L_a_none
    s_mul_i32 s59, s58, 17280
    s_mul_i32 s58, s58, 6400
    v_lshlrev_b32 v4, 7, v1
    s_mov_b64 s[36:37], s[16:17]
    s_mov_b32 s38, 2211840
    s_mov_b32 exec_hi, 0x1fff
    buffer_load_dword v88, v4, s[36:39], s59 offen
    s_add_u32 s59, s59, 5760
    buffer_load_dword v89, v4, s[36:39], s59 offen
    s_add_u32 s59, s59, 5760
    buffer_load_dword v90, v4, s[36:39], s59 offen
    s_add_u32 s59, s59, 5760
    s_mov_b64 s[36:37], s[8:9]
    s_mov_b32 s38, 819200
    s_mov_b32 exec_hi, 0x3ffff
    buffer_load_dword v91, v4, s[36:39], s58 offen
    s_mov_b32 exec_hi, -1
    s_mov_b64 s[36:37], s[18:19]
    s_mov_b32 s38, 1280
    buffer_load_dword v92, v4, s[36:39], 0 offen
    s_branch L_p_go
L_end:
    s_endpgm
.section .rodata,"a"
.p2align 6
.amdhsa_kernel parallel_sum__softmax_full_mha__dense_activation_squared_relu__prompt_kernel
  .amdhsa_next_free_vgpr 256
  .amdhsa_next_free_sgpr 92
  .amdhsa_accum_offset 256
  .amdhsa_group_segment_fixed_size 0
  .amdhsa_kernarg_size 88
  .amdhsa_user_sgpr_count 2
  .amdhsa_user_sgpr_kernarg_segment_ptr 1
  .amdhsa_system_sgpr_workgroup_id_x 1
.end_amdhsa_kernel
```
